```python
import torch

def _softmax(x, axis=-1):
    return torch.softmax(x, dim=axis)
def _gelu(x):
    return torch.nn.functional.gelu(x, approximate="tanh")
def _silu(x):
    return torch.nn.functional.silu(x)
def _sigmoid(x):
    return torch.sigmoid(x)
def _layernorm(x, axis=-1, eps=1e-5):
    m = x.mean(dim=axis, keepdim=True)
    v = x.var(dim=axis, keepdim=True, unbiased=False)
    return (x - m) / torch.sqrt(v + eps)
def _scatter_add(tgt, idx, src, axis=0):
    return tgt.clone().index_add_(axis, idx, src)
def _segment_sum(src, seg, n):
    out = torch.zeros((n,) + src.shape[1:], dtype=src.dtype)
    return out.index_add_(0, seg, src)
def _pad(x, pw):
    flat = tuple(v for pair in reversed(pw) for v in pair)
    return torch.nn.functional.pad(x, flat)

kernel_name = 'gated_mix__sliding_block_cached__glu_gated_reglu__decode'

def setup_inputs():

    _w = (lambda a: (lambda t: t.to(torch.bfloat16) if t.is_floating_point() else t)(torch.as_tensor(a)))
    def _A_setup():
        B, Sq, D = 1, 1, 640
        Hq, Hkv, Sk, Dh = 32, 32, 32768, 192
        assert Hq % Hkv == 0, (Hq, Hkv)
        return {
            "x": _w((lambda *s: torch.randn(*s, dtype=torch.bfloat16) * 0.05)(B, Sq, D)),
            "k_cache": _w((lambda *s: torch.randn(*s, dtype=torch.bfloat16) * 6.4)(B, Hkv, Sk, Dh)),
            "v_cache": _w((lambda *s: torch.randn(*s, dtype=torch.bfloat16) * 0.05)(B, Hkv, Sk, Dh)),
            "wq": _w((lambda *s: torch.randn(*s, dtype=torch.bfloat16) * 6.4)(D, Hq * Dh) * (D ** -0.5)),
            "wo": _w((lambda *s: torch.randn(*s, dtype=torch.bfloat16) * 0.05)(Hq * Dh, D) * ((Hq * Dh) ** -0.5)),
        }
    _A_in = _A_setup()

    def _B_setup():
        B, S, D, F = 1, 1, 640, 1536
        return {
            "x": _w((lambda *s: torch.randn(*s, dtype=torch.bfloat16) * 0.05)(B, S, D)),
            "W_gate": _w((lambda *s: torch.randn(*s, dtype=torch.bfloat16) * 0.4)(D, F) * (2.0 / D) ** 0.5),
            "W_up": _w((lambda *s: torch.randn(*s, dtype=torch.bfloat16) * 0.4)(D, F) * (2.0 / D) ** 0.5),
            "W_down": _w((lambda *s: torch.randn(*s, dtype=torch.bfloat16) * 0.4)(F, D) * (1.0 / F) ** 0.5),
        }
    _B_in = _B_setup()

    return {
        "A_x": _A_in["x"],
        "A_k_cache": _A_in["k_cache"],
        "A_v_cache": _A_in["v_cache"],
        "A_wq": _A_in["wq"],
        "A_wo": _A_in["wo"],
        "B_x": _B_in["x"],
        "B_W_gate": _B_in["W_gate"],
        "B_W_up": _B_in["W_up"],
        "B_W_down": _B_in["W_down"],
        "gate_w": _w((lambda *s: torch.randn(*s, dtype=torch.bfloat16) * 0.1)(640) * 16.0),
    }

def reference(A_x, A_k_cache, A_v_cache, A_wq, A_wo, B_x, B_W_gate, B_W_up, B_W_down, gate_w):
    def _A_ref(x, k_cache, v_cache, wq, wo):
        B, Sq, D = x.shape
        Hq, Dh = 32, 192
        Hkv, Sk = k_cache.shape[1], k_cache.shape[2]
        W = min(4096, max(256, Sk // 4))
        rep = Hq // Hkv
        q = (lambda x, *d: x.permute(*d))((x @ wq).reshape(B, Sq, Hq, Dh), 0, 2, 1, 3)
        k = (lambda x, n, axis: torch.repeat_interleave(x, n, dim=axis))(k_cache[:, :, Sk - W:, :], rep, axis=1)
        v = (lambda x, n, axis: torch.repeat_interleave(x, n, dim=axis))(v_cache[:, :, Sk - W:, :], rep, axis=1)
        scores = torch.einsum("bhqd,bhkd->bhqk", q, k) * (Dh ** -0.5)
        p = _softmax(scores, axis=-1)
        o = torch.einsum("bhqk,bhkd->bhqd", p, v)
        return (lambda x, *d: x.permute(*d))(o, 0, 2, 1, 3).reshape(B, Sq, Hq * Dh) @ wo

    def _B_ref(x, W_gate, W_up, W_down):
        gate = torch.einsum("bsd,df->bsf", x, W_gate)
        up = torch.einsum("bsd,df->bsf", x, W_up)
        gate = gate * (lambda x, dt: x.to(dt))(gate > 0, gate.dtype)
        h = gate * up
        return torch.einsum("bsf,fd->bsd", h, W_down)

    x = A_x
    g = _sigmoid((x * gate_w).sum(-1, keepdims=True))
    a = _A_ref(x, A_k_cache, A_v_cache, A_wq, A_wo)
    b = _B_ref(x, B_W_gate, B_W_up, B_W_down)
    return g * a + (1 - g) * b
```

```asm
; @launch grid=(256,1,1) block=(512,1,1) lds=90368
.amdgcn_target "amdgcn-amd-amdhsa--gfx950"
.text
.globl gated_mix__sliding_block_cached__glu_gated_reglu__decode_kernel
.p2align 8
.type gated_mix__sliding_block_cached__glu_gated_reglu__decode_kernel,@function
gated_mix__sliding_block_cached__glu_gated_reglu__decode_kernel:
    s_cmp_ge_u32 s2, 256
    s_cbranch_scc1 L_end
    s_load_dwordx16 s[4:19], s[0:1], 0
    s_load_dwordx8 s[20:27], s[0:1], 64
    s_load_dwordx2 s[28:29], s[0:1], 96
    s_mov_b32 s76, s2
    s_and_b32 s72, s2, 31
    s_lshr_b32 s73, s2, 5
    v_and_b32 v1, 63, v0
    v_lshrrev_b32 v5, 6, v0
    v_lshlrev_b32 v2, 4, v1
    v_readfirstlane_b32 s74, v5
    v_lshrrev_b32 v3, 5, v1
    v_and_b32 v4, 31, v1
    s_mov_b32 s82, 0x3fb8aa3b
    s_mul_i32 s77, s72, 12582912
    s_lshl_b32 s78, s73, 9
    s_lshl_b32 s79, s74, 6
    s_add_u32 s78, s78, s79
    s_add_u32 s78, s78, 28672
    s_mul_i32 s78, s78, 384
    s_add_u32 s83, s77, s78
    s_mov_b32 s84, s83
    s_mov_b32 s34, 402653184
    s_mov_b32 s35, 0x00020000
    s_waitcnt lgkmcnt(0)
    s_mov_b32 s32, s6
    s_mov_b32 s33, s7
    buffer_load_dwordx4 v[64:67], v2, s[32:35], s83 offen offset:0 nt
    buffer_load_dwordx4 v[68:71], v2, s[32:35], s83 offen offset:1024 nt
    buffer_load_dwordx4 v[72:75], v2, s[32:35], s83 offen offset:2048 nt
    buffer_load_dwordx4 v[76:79], v2, s[32:35], s83 offen offset:3072 nt
    s_load_dword s75, s[28:29], 0
    s_mov_b32 s56, s4
    s_mov_b32 s57, s5
    s_mov_b32 s58, 1280
    s_mov_b32 s59, 0x00020000
    s_mov_b32 s40, s10
    s_mov_b32 s41, s11
    s_mov_b32 s42, 7864320
    s_mov_b32 s43, 0x00020000
    s_lshr_b32 s77, s76, 4
    s_cmp_lt_u32 s77, 8
    s_cselect_b32 s48, s16, s18
    s_cselect_b32 s49, s17, s19
    s_mov_b32 s50, 1966080
    s_mov_b32 s51, 0x00020000
    s_mul_i32 s77, s73, 80
    s_mul_i32 s78, s74, 10
    s_add_u32 s77, s77, s78
    s_lshl_b32 s78, s77, 1
    v_lshlrev_b32 v5, 1, v3
    s_mul_i32 s77, s77, 12288
    s_mul_i32 s79, s72, 384
    s_add_u32 s77, s77, s79
    v_mul_u32_u24 v6, 12288, v3
    v_mul_u32_u24 v7, 12, v4
    v_add_u32 v6, v6, v7
    buffer_load_dwordx3 v[160:162], v6, s[40:43], s77 offen nt
    s_add_u32 s77, s77, 24576
    buffer_load_dwordx3 v[164:166], v6, s[40:43], s77 offen nt
    s_add_u32 s77, s77, 24576
    buffer_load_dwordx3 v[168:170], v6, s[40:43], s77 offen nt
    s_add_u32 s77, s77, 24576
    buffer_load_dwordx3 v[172:174], v6, s[40:43], s77 offen nt
    s_add_u32 s77, s77, 24576
    buffer_load_dwordx3 v[176:178], v6, s[40:43], s77 offen nt
    buffer_load_ushort v200, v5, s[56:59], s78 offen offset:0
    buffer_load_ushort v201, v5, s[56:59], s78 offen offset:4
    buffer_load_ushort v202, v5, s[56:59], s78 offen offset:8
    buffer_load_ushort v203, v5, s[56:59], s78 offen offset:12
    buffer_load_ushort v204, v5, s[56:59], s78 offen offset:16
    s_and_b32 s79, s76, 1
    s_cmp_lg_u32 s79, 0
    s_cbranch_scc1 L_noffn1
    s_lshr_b32 s79, s76, 1
    s_and_b32 s79, s79, 7
    s_mul_i32 s79, s79, 80
    s_mul_i32 s80, s74, 10
    s_add_u32 s79, s79, s80
    s_lshl_b32 s80, s79, 1
    s_mul_i32 s79, s79, 3072
    s_lshr_b32 s78, s76, 4
    s_and_b32 s78, s78, 7
    s_mul_i32 s78, s78, 384
    s_add_u32 s79, s79, s78
    v_mul_u32_u24 v6, 3072, v3
    v_add_u32 v6, v6, v7
    buffer_load_dwordx3 v[180:182], v6, s[48:51], s79 offen nt
    s_add_u32 s79, s79, 6144
    buffer_load_dwordx3 v[184:186], v6, s[48:51], s79 offen nt
    s_add_u32 s79, s79, 6144
    buffer_load_dwordx3 v[188:190], v6, s[48:51], s79 offen nt
    s_add_u32 s79, s79, 6144
    buffer_load_dwordx3 v[192:194], v6, s[48:51], s79 offen nt
    s_add_u32 s79, s79, 6144
    buffer_load_dwordx3 v[196:198], v6, s[48:51], s79 offen nt
    buffer_load_ushort v205, v5, s[56:59], s80 offen offset:0
    buffer_load_ushort v206, v5, s[56:59], s80 offen offset:4
    buffer_load_ushort v207, v5, s[56:59], s80 offen offset:8
    buffer_load_ushort v208, v5, s[56:59], s80 offen offset:12
    buffer_load_ushort v209, v5, s[56:59], s80 offen offset:16
L_noffn1:
    s_mov_b32 s60, s22
    s_mov_b32 s61, s23
    s_mov_b32 s62, 1280
    s_mov_b32 s63, 0x00020000
    s_cmp_lg_u32 s74, 5
    s_cbranch_scc1 L_nog1
    v_lshlrev_b32 v5, 2, v1
    buffer_load_dword v210, v5, s[56:59], 0 offen offset:0
    buffer_load_dword v215, v5, s[60:63], 0 offen offset:0
    buffer_load_dword v211, v5, s[56:59], 0 offen offset:256
    buffer_load_dword v216, v5, s[60:63], 0 offen offset:256
    buffer_load_dword v212, v5, s[56:59], 0 offen offset:512
    buffer_load_dword v217, v5, s[60:63], 0 offen offset:512
    buffer_load_dword v213, v5, s[56:59], 0 offen offset:768
    buffer_load_dword v218, v5, s[60:63], 0 offen offset:768
    buffer_load_dword v214, v5, s[56:59], 0 offen offset:1024
    buffer_load_dword v219, v5, s[60:63], 0 offen offset:1024
L_nog1:
    s_add_u32 s83, s83, 4096
    buffer_load_dwordx4 v[80:83], v2, s[32:35], s83 offen offset:0 nt
    buffer_load_dwordx4 v[84:87], v2, s[32:35], s83 offen offset:1024 nt
    s_mov_b32 s36, s8
    s_mov_b32 s37, s9
    s_mov_b32 s38, 402653184
    s_mov_b32 s39, 0x00020000
    s_mov_b32 s44, s12
    s_mov_b32 s45, s13
    s_mov_b32 s46, 7864320
    s_mov_b32 s47, 0x00020000
    s_mov_b32 s52, s20
    s_mov_b32 s53, s21
    s_mov_b32 s54, 1966080
    s_mov_b32 s55, 0x00020000
    s_mov_b32 s64, s24
    s_mov_b32 s65, s25
    s_mov_b32 s66, 1280
    s_mov_b32 s67, 0x00020000
    s_mov_b32 s68, s28
    s_mov_b32 s69, s29
    s_mov_b32 s70, 2756608
    s_mov_b32 s71, 0x00020000
    v_mov_b32 v5, 27968
    v_mov_b32 v6, 0
    v_mov_b32 v7, 0
    ds_write_b64 v5, v[6:7]
    ds_write_b64 v5, v[6:7] offset:8
    s_waitcnt lgkmcnt(0)
    s_barrier
    s_waitcnt vmcnt(2)
    v_lshlrev_b32 v20, 16, v200
    v_lshlrev_b32 v21, 16, v201
    v_lshlrev_b32 v22, 16, v202
    v_lshlrev_b32 v23, 16, v203
    v_lshlrev_b32 v24, 16, v204
    v_lshlrev_b32 v25, 16, v205
    v_lshlrev_b32 v26, 16, v206
    v_lshlrev_b32 v27, 16, v207
    v_lshlrev_b32 v28, 16, v208
    v_lshlrev_b32 v29, 16, v209
    v_dot2_f32_bf16 v8, v160, v200, 0
    v_dot2_f32_bf16 v9, v160, v20, 0
    v_dot2_f32_bf16 v10, v161, v200, 0
    v_dot2_f32_bf16 v11, v161, v20, 0
    v_dot2_f32_bf16 v12, v162, v200, 0
    v_dot2_f32_bf16 v13, v162, v20, 0
    v_dot2_f32_bf16 v8, v164, v201, v8
    v_dot2_f32_bf16 v9, v164, v21, v9
    v_dot2_f32_bf16 v10, v165, v201, v10
    v_dot2_f32_bf16 v11, v165, v21, v11
    v_dot2_f32_bf16 v12, v166, v201, v12
    v_dot2_f32_bf16 v13, v166, v21, v13
    v_dot2_f32_bf16 v8, v168, v202, v8
    v_dot2_f32_bf16 v9, v168, v22, v9
    v_dot2_f32_bf16 v10, v169, v202, v10
    v_dot2_f32_bf16 v11, v169, v22, v11
    v_dot2_f32_bf16 v12, v170, v202, v12
    v_dot2_f32_bf16 v13, v170, v22, v13
    v_dot2_f32_bf16 v8, v172, v203, v8
    v_dot2_f32_bf16 v9, v172, v23, v9
    v_dot2_f32_bf16 v10, v173, v203, v10
    v_dot2_f32_bf16 v11, v173, v23, v11
    v_dot2_f32_bf16 v12, v174, v203, v12
    v_dot2_f32_bf16 v13, v174, v23, v13
    v_dot2_f32_bf16 v8, v176, v204, v8
    v_dot2_f32_bf16 v9, v176, v24, v9
    v_dot2_f32_bf16 v10, v177, v204, v10
    v_dot2_f32_bf16 v11, v177, v24, v11
    v_dot2_f32_bf16 v12, v178, v204, v12
    v_dot2_f32_bf16 v13, v178, v24, v13
    v_dot2_f32_bf16 v14, v180, v205, 0
    v_dot2_f32_bf16 v15, v180, v25, 0
    v_dot2_f32_bf16 v16, v181, v205, 0
    v_dot2_f32_bf16 v17, v181, v25, 0
    v_dot2_f32_bf16 v18, v182, v205, 0
    v_dot2_f32_bf16 v19, v182, v25, 0
    v_dot2_f32_bf16 v14, v184, v206, v14
    v_dot2_f32_bf16 v15, v184, v26, v15
    v_dot2_f32_bf16 v16, v185, v206, v16
    v_dot2_f32_bf16 v17, v185, v26, v17
    v_dot2_f32_bf16 v18, v186, v206, v18
    v_dot2_f32_bf16 v19, v186, v26, v19
    v_dot2_f32_bf16 v14, v188, v207, v14
    v_dot2_f32_bf16 v15, v188, v27, v15
    v_dot2_f32_bf16 v16, v189, v207, v16
    v_dot2_f32_bf16 v17, v189, v27, v17
    v_dot2_f32_bf16 v18, v190, v207, v18
    v_dot2_f32_bf16 v19, v190, v27, v19
    v_dot2_f32_bf16 v14, v192, v208, v14
    v_dot2_f32_bf16 v15, v192, v28, v15
    v_dot2_f32_bf16 v16, v193, v208, v16
    v_dot2_f32_bf16 v17, v193, v28, v17
    v_dot2_f32_bf16 v18, v194, v208, v18
    v_dot2_f32_bf16 v19, v194, v28, v19
    v_dot2_f32_bf16 v14, v196, v209, v14
    v_dot2_f32_bf16 v15, v196, v29, v15
    v_dot2_f32_bf16 v16, v197, v209, v16
    v_dot2_f32_bf16 v17, v197, v29, v17
    v_dot2_f32_bf16 v18, v198, v209, v18
    v_dot2_f32_bf16 v19, v198, v29, v19
    s_lshl_b32 s77, s74, 1
    v_add_u32 v5, s77, v3
    v_mul_u32_u24 v5, 1536, v5
    v_mul_u32_u24 v6, 24, v4
    v_add_u32 v5, v5, v6
    s_nop 1
    ds_write_b64 v5, v[8:9] offset:0
    ds_write_b64 v5, v[10:11] offset:8
    ds_write_b64 v5, v[12:13] offset:16
    ds_write_b64 v5, v[14:15] offset:768
    ds_write_b64 v5, v[16:17] offset:776
    ds_write_b64 v5, v[18:19] offset:784
    s_cmp_lg_u32 s74, 5
    s_cbranch_scc1 L_nog2
    v_mov_b32 v35, 0
    v_lshlrev_b32 v32, 16, v210
    v_lshlrev_b32 v33, 16, v215
    v_mul_f32 v32, v32, v33
    v_and_b32 v33, 0xffff0000, v210
    v_and_b32 v34, 0xffff0000, v215
    v_mul_f32 v33, v33, v34
    v_cvt_pk_bf16_f32 v32, v32, v33
    v_and_b32 v33, 0xffff0000, v32
    v_lshlrev_b32 v32, 16, v32
    v_add_f32 v35, v35, v32
    v_add_f32 v35, v35, v33
    v_lshlrev_b32 v32, 16, v211
    v_lshlrev_b32 v33, 16, v216
    v_mul_f32 v32, v32, v33
    v_and_b32 v33, 0xffff0000, v211
    v_and_b32 v34, 0xffff0000, v216
    v_mul_f32 v33, v33, v34
    v_cvt_pk_bf16_f32 v32, v32, v33
    v_and_b32 v33, 0xffff0000, v32
    v_lshlrev_b32 v32, 16, v32
    v_add_f32 v35, v35, v32
    v_add_f32 v35, v35, v33
    v_lshlrev_b32 v32, 16, v212
    v_lshlrev_b32 v33, 16, v217
    v_mul_f32 v32, v32, v33
    v_and_b32 v33, 0xffff0000, v212
    v_and_b32 v34, 0xffff0000, v217
    v_mul_f32 v33, v33, v34
    v_cvt_pk_bf16_f32 v32, v32, v33
    v_and_b32 v33, 0xffff0000, v32
    v_lshlrev_b32 v32, 16, v32
    v_add_f32 v35, v35, v32
    v_add_f32 v35, v35, v33
    v_lshlrev_b32 v32, 16, v213
    v_lshlrev_b32 v33, 16, v218
    v_mul_f32 v32, v32, v33
    v_and_b32 v33, 0xffff0000, v213
    v_and_b32 v34, 0xffff0000, v218
    v_mul_f32 v33, v33, v34
    v_cvt_pk_bf16_f32 v32, v32, v33
    v_and_b32 v33, 0xffff0000, v32
    v_lshlrev_b32 v32, 16, v32
    v_add_f32 v35, v35, v32
    v_add_f32 v35, v35, v33
    v_lshlrev_b32 v32, 16, v214
    v_lshlrev_b32 v33, 16, v219
    v_mul_f32 v32, v32, v33
    v_and_b32 v33, 0xffff0000, v214
    v_and_b32 v34, 0xffff0000, v219
    v_mul_f32 v33, v33, v34
    v_cvt_pk_bf16_f32 v32, v32, v33
    v_and_b32 v33, 0xffff0000, v32
    v_lshlrev_b32 v32, 16, v32
    v_add_f32 v35, v35, v32
    v_add_f32 v35, v35, v33
    s_nop 1
    v_add_f32_dpp v35, v35, v35 quad_perm:[1,0,3,2] row_mask:0xf bank_mask:0xf
    s_nop 1
    v_add_f32_dpp v35, v35, v35 quad_perm:[2,3,0,1] row_mask:0xf bank_mask:0xf
    s_nop 1
    v_add_f32_dpp v35, v35, v35 row_half_mirror row_mask:0xf bank_mask:0xf
    s_nop 1
    v_add_f32_dpp v35, v35, v35 row_mirror row_mask:0xf bank_mask:0xf
    v_mov_b32 v32, v35
    s_nop 1
    v_permlane16_swap_b32 v35, v32
    s_nop 1
    v_add_f32 v35, v35, v32
    v_mov_b32 v32, v35
    s_nop 1
    v_permlane32_swap_b32 v35, v32
    s_nop 1
    v_add_f32 v35, v35, v32
    v_cvt_pk_bf16_f32 v35, v35, v35
    v_and_b32 v35, 0xffff0000, v35
    v_mul_f32 v35, s82, v35
    v_sub_f32 v35, 0, v35
    v_exp_f32 v35, v35
    s_nop 0
    v_add_f32 v35, 1.0, v35
    v_rcp_f32 v35, v35
    s_nop 0
    v_cvt_pk_bf16_f32 v35, v35, v35
    v_and_b32 v35, 0xffff0000, v35
    v_sub_f32 v34, 1.0, v35
    v_cvt_pk_bf16_f32 v34, v34, v34
    v_and_b32 v34, 0xffff0000, v34
    v_mov_b32 v32, v35
    v_mov_b32 v33, v34
    v_mov_b32 v35, 27200
    ds_write_b64 v35, v[32:33]
L_nog2:
    s_waitcnt lgkmcnt(0)
    v_mov_b32 v5, 27972
    v_mov_b32 v6, 1
    s_mov_b64 exec, 1
    ds_add_u32 v5, v6
    s_mov_b64 exec, -1
    s_add_u32 s75, s75, 1
    s_sub_u32 s78, s74, 2
    s_cmp_ge_u32 s78, 3
    s_cbranch_scc1 L_krest
    s_setprio 3
    s_mov_b32 s81, 0
L_await:
    ds_read_b32 v6, v5
    s_waitcnt lgkmcnt(0)
    v_readfirstlane_b32 s78, v6
    s_cmp_eq_u32 s78, 8
    s_cbranch_scc1 L_aready
    s_add_u32 s81, s81, 1
    s_cmp_gt_u32 s81, 4000000
    s_cbranch_scc1 L_aready
    s_branch L_await
L_aready:
    v_subrev_u32 v7, 128, v0
    v_lshlrev_b32 v5, 3, v7
    ds_read_b64 v[32:33], v5 offset:0
    ds_read_b64 v[34:35], v5 offset:1536
    ds_read_b64 v[36:37], v5 offset:3072
    ds_read_b64 v[38:39], v5 offset:4608
    ds_read_b64 v[40:41], v5 offset:6144
    ds_read_b64 v[42:43], v5 offset:7680
    ds_read_b64 v[44:45], v5 offset:9216
    ds_read_b64 v[46:47], v5 offset:10752
    ds_read_b64 v[48:49], v5 offset:12288
    ds_read_b64 v[50:51], v5 offset:13824
    ds_read_b64 v[52:53], v5 offset:15360
    ds_read_b64 v[54:55], v5 offset:16896
    ds_read_b64 v[56:57], v5 offset:18432
    ds_read_b64 v[58:59], v5 offset:19968
    ds_read_b64 v[60:61], v5 offset:21504
    ds_read_b64 v[62:63], v5 offset:23040
    s_waitcnt lgkmcnt(14)
    v_add_f32 v32, v32, v34
    v_add_f32 v33, v33, v35
    s_waitcnt lgkmcnt(13)
    v_add_f32 v32, v32, v36
    v_add_f32 v33, v33, v37
    s_waitcnt lgkmcnt(12)
    v_add_f32 v32, v32, v38
    v_add_f32 v33, v33, v39
    s_waitcnt lgkmcnt(11)
    v_add_f32 v32, v32, v40
    v_add_f32 v33, v33, v41
    s_waitcnt lgkmcnt(10)
    v_add_f32 v32, v32, v42
    v_add_f32 v33, v33, v43
    s_waitcnt lgkmcnt(9)
    v_add_f32 v32, v32, v44
    v_add_f32 v33, v33, v45
    s_waitcnt lgkmcnt(8)
    v_add_f32 v32, v32, v46
    v_add_f32 v33, v33, v47
    s_waitcnt lgkmcnt(7)
    v_add_f32 v32, v32, v48
    v_add_f32 v33, v33, v49
    s_waitcnt lgkmcnt(6)
    v_add_f32 v32, v32, v50
    v_add_f32 v33, v33, v51
    s_waitcnt lgkmcnt(5)
    v_add_f32 v32, v32, v52
    v_add_f32 v33, v33, v53
    s_waitcnt lgkmcnt(4)
    v_add_f32 v32, v32, v54
    v_add_f32 v33, v33, v55
    s_waitcnt lgkmcnt(3)
    v_add_f32 v32, v32, v56
    v_add_f32 v33, v33, v57
    s_waitcnt lgkmcnt(2)
    v_add_f32 v32, v32, v58
    v_add_f32 v33, v33, v59
    s_waitcnt lgkmcnt(1)
    v_add_f32 v32, v32, v60
    v_add_f32 v33, v33, v61
    s_waitcnt lgkmcnt(0)
    v_add_f32 v32, v32, v62
    v_add_f32 v33, v33, v63
    v_mov_b32 v34, v33
    v_mov_b32 v33, s75
    v_mov_b32 v35, s75
    s_mul_i32 s77, s76, 3072
    s_add_u32 s77, s77, 4096
    v_lshlrev_b32 v5, 4, v7
    s_and_b32 s78, s76, 1
    s_cmp_eq_u32 s78, 0
    s_cselect_b32 s78, 2, 1
    s_mul_i32 s78, s78, 96
    v_cmp_gt_u32 vcc, s78, v7
    s_and_saveexec_b64 s[88:89], vcc
    s_cbranch_execz L_nopst
    buffer_store_dwordx4 v[32:35], v5, s[68:71], s77 offen sc1
L_nopst:
    s_mov_b64 exec, s[88:89]
    s_setprio 0
L_krest:
    s_cmp_ge_u32 s74, 2
    s_cbranch_scc1 L_noprio
    s_setprio 2
L_noprio:
    buffer_load_dwordx4 v[88:91], v2, s[32:35], s83 offen offset:2048 nt
    buffer_load_dwordx4 v[92:95], v2, s[32:35], s83 offen offset:3072 nt
    s_add_u32 s83, s83, 4096
    buffer_load_dwordx4 v[96:99], v2, s[32:35], s83 offen offset:0 nt
    buffer_load_dwordx4 v[100:103], v2, s[32:35], s83 offen offset:1024 nt
    buffer_load_dwordx4 v[104:107], v2, s[32:35], s83 offen offset:2048 nt
    buffer_load_dwordx4 v[108:111], v2, s[32:35], s83 offen offset:3072 nt
    s_add_u32 s83, s83, 4096
    buffer_load_dwordx4 v[112:115], v2, s[32:35], s83 offen offset:0 nt
    buffer_load_dwordx4 v[116:119], v2, s[32:35], s83 offen offset:1024 nt
    buffer_load_dwordx4 v[120:123], v2, s[32:35], s83 offen offset:2048 nt
    buffer_load_dwordx4 v[124:127], v2, s[32:35], s83 offen offset:3072 nt
    s_add_u32 s83, s83, 4096
    buffer_load_dwordx4 v[128:131], v2, s[32:35], s83 offen offset:0 nt
    buffer_load_dwordx4 v[132:135], v2, s[32:35], s83 offen offset:1024 nt
    buffer_load_dwordx4 v[136:139], v2, s[32:35], s83 offen offset:2048 nt
    buffer_load_dwordx4 v[140:143], v2, s[32:35], s83 offen offset:3072 nt
    s_add_u32 s83, s83, 4096
    buffer_load_dwordx4 v[144:147], v2, s[32:35], s83 offen offset:0 nt
    buffer_load_dwordx4 v[148:151], v2, s[32:35], s83 offen offset:1024 nt
    buffer_load_dwordx4 v[152:155], v2, s[32:35], s83 offen offset:2048 nt
    buffer_load_dwordx4 v[156:159], v2, s[32:35], s83 offen offset:3072 nt
    s_barrier
    buffer_load_dwordx4 v[160:163], v2, s[36:39], s84 offen offset:0 nt
    buffer_load_dwordx4 v[164:167], v2, s[36:39], s84 offen offset:1024 nt
    buffer_load_dwordx4 v[168:171], v2, s[36:39], s84 offen offset:2048 nt
    buffer_load_dwordx4 v[172:175], v2, s[36:39], s84 offen offset:3072 nt
    s_add_u32 s84, s84, 4096
    buffer_load_dwordx4 v[176:179], v2, s[36:39], s84 offen offset:0 nt
    buffer_load_dwordx4 v[180:183], v2, s[36:39], s84 offen offset:1024 nt
    buffer_load_dwordx4 v[184:187], v2, s[36:39], s84 offen offset:2048 nt
    buffer_load_dwordx4 v[188:191], v2, s[36:39], s84 offen offset:3072 nt
    s_add_u32 s84, s84, 4096
    buffer_load_dwordx4 v[192:195], v2, s[36:39], s84 offen offset:0 nt
    buffer_load_dwordx4 v[196:199], v2, s[36:39], s84 offen offset:1024 nt
    buffer_load_dwordx4 v[200:203], v2, s[36:39], s84 offen offset:2048 nt
    buffer_load_dwordx4 v[204:207], v2, s[36:39], s84 offen offset:3072 nt
    s_add_u32 s84, s84, 4096
    buffer_load_dwordx4 v[208:211], v2, s[36:39], s84 offen offset:0 nt
    buffer_load_dwordx4 v[212:215], v2, s[36:39], s84 offen offset:1024 nt
    buffer_load_dwordx4 v[216:219], v2, s[36:39], s84 offen offset:2048 nt
    buffer_load_dwordx4 v[220:223], v2, s[36:39], s84 offen offset:3072 nt
    s_cmp_ge_u32 s74, 2
    s_cbranch_scc1 L_nocomm
    s_mul_i32 s77, s72, 3072
    s_add_u32 s77, s77, 4096
    s_mov_b32 s81, 0
    s_cmp_eq_u32 s74, 1
    s_cbranch_scc1 L_commB
    v_bfe_u32 v10, v1, 3, 1
    v_mul_u32_u24 v10, 393216, v10
    v_and_b32 v5, 7, v1
    v_mul_u32_u24 v5, 6144, v5
    v_add_u32 v10, v10, v5
    v_lshrrev_b32 v5, 4, v1
    v_and_b32 v6, 1, v5
    v_lshl_add_u32 v11, v6, 4, v10
    v_add_u32 v11, 64, v11
    v_lshl_add_u32 v10, v5, 4, v10
    s_lshl_b32 s78, s72, 2
    s_lshr_b32 s79, s73, 1
    s_add_u32 s78, s78, s79
    s_lshr_b32 s79, s78, 4
    s_mul_i32 s79, s79, 49152
    s_and_b32 s78, s78, 15
    s_mul_i32 s78, s78, 96
    s_add_u32 s78, s78, s79
    s_add_u32 s78, s78, 5632
L_poll0:
    s_mov_b32 s79, s77
    buffer_load_dwordx4 v[32:35], v2, s[68:71], s79 offen sc1
    s_add_u32 s79, s79, 98304
    buffer_load_dwordx4 v[36:39], v2, s[68:71], s79 offen sc1
    s_add_u32 s79, s79, 98304
    buffer_load_dwordx4 v[40:43], v2, s[68:71], s79 offen sc1
    s_add_u32 s79, s79, 98304
    buffer_load_dwordx4 v[44:47], v2, s[68:71], s79 offen sc1
    s_add_u32 s79, s79, 98304
    buffer_load_dwordx4 v[48:51], v2, s[68:71], s79 offen sc1
    s_add_u32 s79, s79, 98304
    buffer_load_dwordx4 v[52:55], v2, s[68:71], s79 offen sc1
    s_add_u32 s79, s79, 98304
    buffer_load_dwordx4 v[56:59], v2, s[68:71], s79 offen sc1
    s_add_u32 s79, s79, 98304
    buffer_load_dwordx4 v[60:63], v2, s[68:71], s79 offen sc1
    buffer_load_dwordx4 v[12:15], v10, s[68:71], s78 offen sc1
    buffer_load_dwordx4 v[16:19], v11, s[68:71], s78 offen sc1
    s_waitcnt vmcnt(0)
    v_xor_b32 v5, s75, v33
    v_xor_b32 v6, s75, v35
    v_or_b32 v5, v5, v6
    v_xor_b32 v6, s75, v37
    v_or_b32 v5, v5, v6
    v_xor_b32 v6, s75, v39
    v_or_b32 v5, v5, v6
    v_xor_b32 v6, s75, v41
    v_or_b32 v5, v5, v6
    v_xor_b32 v6, s75, v43
    v_or_b32 v5, v5, v6
    v_xor_b32 v6, s75, v45
    v_or_b32 v5, v5, v6
    v_xor_b32 v6, s75, v47
    v_or_b32 v5, v5, v6
    v_xor_b32 v6, s75, v49
    v_or_b32 v5, v5, v6
    v_xor_b32 v6, s75, v51
    v_or_b32 v5, v5, v6
    v_xor_b32 v6, s75, v53
    v_or_b32 v5, v5, v6
    v_xor_b32 v6, s75, v55
    v_or_b32 v5, v5, v6
    v_xor_b32 v6, s75, v57
    v_or_b32 v5, v5, v6
    v_xor_b32 v6, s75, v59
    v_or_b32 v5, v5, v6
    v_xor_b32 v6, s75, v61
    v_or_b32 v5, v5, v6
    v_xor_b32 v6, s75, v63
    v_or_b32 v5, v5, v6
    v_xor_b32 v6, s75, v13
    v_or_b32 v5, v5, v6
    v_xor_b32 v6, s75, v15
    v_or_b32 v5, v5, v6
    v_xor_b32 v6, s75, v17
    v_or_b32 v5, v5, v6
    v_xor_b32 v6, s75, v19
    v_or_b32 v5, v5, v6
    v_cmp_ne_u32 vcc, 0, v5
    s_nop 1
    s_cmp_eq_u64 vcc, 0
    s_cbranch_scc1 L_pd_1
    s_add_u32 s81, s81, 1
    s_cmp_lt_u32 s81, 200000
    s_cbranch_scc0 L_pd_1
    s_branch L_poll0
L_pd_1:
    v_add_f32 v32, v32, v36
    v_add_f32 v34, v34, v38
    v_add_f32 v32, v32, v40
    v_add_f32 v34, v34, v42
    v_add_f32 v32, v32, v44
    v_add_f32 v34, v34, v46
    v_add_f32 v32, v32, v48
    v_add_f32 v34, v34, v50
    v_add_f32 v32, v32, v52
    v_add_f32 v34, v34, v54
    v_add_f32 v32, v32, v56
    v_add_f32 v34, v34, v58
    v_add_f32 v32, v32, v60
    v_add_f32 v34, v34, v62
    v_cvt_pk_bf16_f32 v32, v32, v34
    v_lshlrev_b32 v5, 2, v1
    ds_write_b32 v5, v32 offset:26624
    s_nop 1
    v_add_f32_dpp v12, v12, v12 quad_perm:[1,0,3,2] row_mask:0xf bank_mask:0xf
    v_add_f32_dpp v14, v14, v14 quad_perm:[1,0,3,2] row_mask:0xf bank_mask:0xf
    v_add_f32_dpp v16, v16, v16 quad_perm:[1,0,3,2] row_mask:0xf bank_mask:0xf
    v_add_f32_dpp v18, v18, v18 quad_perm:[1,0,3,2] row_mask:0xf bank_mask:0xf
    s_nop 1
    v_add_f32_dpp v12, v12, v12 quad_perm:[2,3,0,1] row_mask:0xf bank_mask:0xf
    v_add_f32_dpp v14, v14, v14 quad_perm:[2,3,0,1] row_mask:0xf bank_mask:0xf
    v_add_f32_dpp v16, v16, v16 quad_perm:[2,3,0,1] row_mask:0xf bank_mask:0xf
    v_add_f32_dpp v18, v18, v18 quad_perm:[2,3,0,1] row_mask:0xf bank_mask:0xf
    s_nop 1
    v_add_f32_dpp v12, v12, v12 row_half_mirror row_mask:0xf bank_mask:0xf
    v_add_f32_dpp v14, v14, v14 row_half_mirror row_mask:0xf bank_mask:0xf
    v_add_f32_dpp v16, v16, v16 row_half_mirror row_mask:0xf bank_mask:0xf
    v_add_f32_dpp v18, v18, v18 row_half_mirror row_mask:0xf bank_mask:0xf
    s_nop 1
    v_mov_b32_dpp v13, v12 row_ror:8 row_mask:0xf bank_mask:0xf
    v_mov_b32_dpp v15, v14 row_ror:8 row_mask:0xf bank_mask:0xf
    v_mov_b32_dpp v17, v16 row_ror:8 row_mask:0xf bank_mask:0xf
    v_mov_b32_dpp v19, v18 row_ror:8 row_mask:0xf bank_mask:0xf
    v_cvt_pk_bf16_f32 v12, v12, v12
    v_and_b32 v12, 0xffff0000, v12
    v_cvt_pk_bf16_f32 v13, v13, v13
    v_and_b32 v13, 0xffff0000, v13
    v_max_f32 v12, 0, v12
    v_mul_f32 v12, v12, v13
    v_cvt_pk_bf16_f32 v12, v12, v12
    v_and_b32 v12, 0xffff0000, v12
    v_cvt_pk_bf16_f32 v14, v14, v14
    v_and_b32 v14, 0xffff0000, v14
    v_cvt_pk_bf16_f32 v15, v15, v15
    v_and_b32 v15, 0xffff0000, v15
    v_max_f32 v14, 0, v14
    v_mul_f32 v14, v14, v15
    v_cvt_pk_bf16_f32 v14, v14, v14
    v_and_b32 v14, 0xffff0000, v14
    v_cvt_pk_bf16_f32 v16, v16, v16
    v_and_b32 v16, 0xffff0000, v16
    v_cvt_pk_bf16_f32 v17, v17, v17
    v_and_b32 v17, 0xffff0000, v17
    v_max_f32 v16, 0, v16
    v_mul_f32 v16, v16, v17
    v_cvt_pk_bf16_f32 v16, v16, v16
    v_and_b32 v16, 0xffff0000, v16
    v_cvt_pk_bf16_f32 v18, v18, v18
    v_and_b32 v18, 0xffff0000, v18
    v_cvt_pk_bf16_f32 v19, v19, v19
    v_and_b32 v19, 0xffff0000, v19
    v_max_f32 v18, 0, v18
    v_mul_f32 v18, v18, v19
    v_cvt_pk_bf16_f32 v18, v18, v18
    v_and_b32 v18, 0xffff0000, v18
    v_lshrrev_b32 v5, 4, v1
    v_lshlrev_b32 v5, 3, v5
    s_mov_b32 exec_lo, 0x00010001
    s_mov_b32 exec_hi, 0x00010001
    ds_write_b32 v5, v12 offset:27136
    ds_write_b32 v5, v14 offset:27140
    s_mov_b32 exec_hi, 0
    ds_write_b32 v5, v16 offset:27168
    ds_write_b32 v5, v18 offset:27172
    s_mov_b64 exec, -1
    v_mov_b32 v6, 0
    v_mov_b32 v5, 27136
    ds_write_b32 v5, v6 offset:48
    ds_write_b32 v5, v6 offset:52
    ds_write_b32 v5, v6 offset:56
    ds_write_b32 v5, v6 offset:60
    s_branch L_commdone
L_commB:
    v_lshlrev_b32 v9, 4, v4
    v_add_u32 v9, 1024, v9
L_poll0b:
    s_mov_b32 s79, s77
    buffer_load_dwordx4 v[32:35], v9, s[68:71], s79 offen sc1
    s_add_u32 s79, s79, 98304
    buffer_load_dwordx4 v[36:39], v9, s[68:71], s79 offen sc1
    s_add_u32 s79, s79, 98304
    buffer_load_dwordx4 v[40:43], v9, s[68:71], s79 offen sc1
    s_add_u32 s79, s79, 98304
    buffer_load_dwordx4 v[44:47], v9, s[68:71], s79 offen sc1
    s_add_u32 s79, s79, 98304
    buffer_load_dwordx4 v[48:51], v9, s[68:71], s79 offen sc1
    s_add_u32 s79, s79, 98304
    buffer_load_dwordx4 v[52:55], v9, s[68:71], s79 offen sc1
    s_add_u32 s79, s79, 98304
    buffer_load_dwordx4 v[56:59], v9, s[68:71], s79 offen sc1
    s_add_u32 s79, s79, 98304
    buffer_load_dwordx4 v[60:63], v9, s[68:71], s79 offen sc1
    s_waitcnt vmcnt(0)
    v_xor_b32 v5, s75, v33
    v_xor_b32 v6, s75, v35
    v_or_b32 v5, v5, v6
    v_xor_b32 v6, s75, v37
    v_or_b32 v5, v5, v6
    v_xor_b32 v6, s75, v39
    v_or_b32 v5, v5, v6
    v_xor_b32 v6, s75, v41
    v_or_b32 v5, v5, v6
    v_xor_b32 v6, s75, v43
    v_or_b32 v5, v5, v6
    v_xor_b32 v6, s75, v45
    v_or_b32 v5, v5, v6
    v_xor_b32 v6, s75, v47
    v_or_b32 v5, v5, v6
    v_xor_b32 v6, s75, v49
    v_or_b32 v5, v5, v6
    v_xor_b32 v6, s75, v51
    v_or_b32 v5, v5, v6
    v_xor_b32 v6, s75, v53
    v_or_b32 v5, v5, v6
    v_xor_b32 v6, s75, v55
    v_or_b32 v5, v5, v6
    v_xor_b32 v6, s75, v57
    v_or_b32 v5, v5, v6
    v_xor_b32 v6, s75, v59
    v_or_b32 v5, v5, v6
    v_xor_b32 v6, s75, v61
    v_or_b32 v5, v5, v6
    v_xor_b32 v6, s75, v63
    v_or_b32 v5, v5, v6
    v_cmp_ne_u32 vcc, 0, v5
    s_nop 1
    s_cmp_eq_u64 vcc, 0
    s_cbranch_scc1 L_pd_2
    s_add_u32 s81, s81, 1
    s_cmp_lt_u32 s81, 200000
    s_cbranch_scc0 L_pd_2
    s_branch L_poll0b
L_pd_2:
    v_add_f32 v32, v32, v36
    v_add_f32 v34, v34, v38
    v_add_f32 v32, v32, v40
    v_add_f32 v34, v34, v42
    v_add_f32 v32, v32, v44
    v_add_f32 v34, v34, v46
    v_add_f32 v32, v32, v48
    v_add_f32 v34, v34, v50
    v_add_f32 v32, v32, v52
    v_add_f32 v34, v34, v54
    v_add_f32 v32, v32, v56
    v_add_f32 v34, v34, v58
    v_add_f32 v32, v32, v60
    v_add_f32 v34, v34, v62
    v_cvt_pk_bf16_f32 v32, v32, v34
    v_lshlrev_b32 v6, 2, v4
    ds_write_b32 v6, v32 offset:26880
L_commdone:
    s_waitcnt lgkmcnt(0)
    v_mov_b32 v5, 27968
    v_mov_b32 v6, 1
    s_mov_b64 exec, 1
    ds_add_u32 v5, v6
    s_mov_b64 exec, -1
L_nocomm:
    v_add_u32 v5, 0, v1
    v_mul_u32_u24 v20, 2731, v5
    v_lshrrev_b32 v20, 16, v20
    v_mul_u32_u24 v6, 24, v20
    v_sub_u32 v23, v5, v6
    v_add_u32 v5, 64, v1
    v_mul_u32_u24 v21, 2731, v5
    v_lshrrev_b32 v21, 16, v21
    v_mul_u32_u24 v6, 24, v21
    v_sub_u32 v24, v5, v6
    v_add_u32 v5, 128, v1
    v_mul_u32_u24 v22, 2731, v5
    v_lshrrev_b32 v22, 16, v22
    v_mul_u32_u24 v6, 24, v22
    v_sub_u32 v25, v5, v6
    s_mul_i32 s77, s74, 7200
    s_add_u32 s77, s77, 32768
    v_mul_u32_u24 v5, 112, v20
    v_lshl_add_u32 v5, v23, 2, v5
    v_add_u32 v26, s77, v5
    v_mul_u32_u24 v5, 112, v21
    v_lshl_add_u32 v5, v24, 2, v5
    v_add_u32 v27, s77, v5
    v_mul_u32_u24 v5, 112, v22
    v_lshl_add_u32 v5, v25, 2, v5
    v_add_u32 v28, s77, v5
    v_mov_b32 v5, 27968
    s_mov_b32 s81, 0
L_qwait:
    ds_read_b32 v6, v5
    s_waitcnt lgkmcnt(0)
    v_readfirstlane_b32 s78, v6
    s_cmp_eq_u32 s78, 2
    s_cbranch_scc1 L_qready
    s_add_u32 s81, s81, 1
    s_cmp_gt_u32 s81, 4000000
    s_cbranch_scc1 L_qready
    s_sleep 1
    s_branch L_qwait
L_qready:
    v_lshlrev_b32 v5, 4, v23
    ds_read_b128 v[8:11], v5 offset:26624
    v_lshlrev_b32 v5, 4, v24
    ds_read_b128 v[12:15], v5 offset:26624
    v_lshlrev_b32 v5, 4, v25
    ds_read_b128 v[16:19], v5 offset:26624
    s_waitcnt lgkmcnt(0)
    s_waitcnt vmcnt(39)
    v_dot2_f32_bf16 v29, v64, v8, 0
    v_dot2_f32_bf16 v29, v65, v9, v29
    v_dot2_f32_bf16 v29, v66, v10, v29
    v_dot2_f32_bf16 v29, v67, v11, v29
    s_waitcnt vmcnt(38)
    v_dot2_f32_bf16 v30, v68, v12, 0
    v_dot2_f32_bf16 v30, v69, v13, v30
    v_dot2_f32_bf16 v30, v70, v14, v30
    v_dot2_f32_bf16 v30, v71, v15, v30
    ds_write_b32 v26, v29 offset:0
    s_waitcnt vmcnt(37)
    v_dot2_f32_bf16 v31, v72, v16, 0
    v_dot2_f32_bf16 v31, v73, v17, v31
    v_dot2_f32_bf16 v31, v74, v18, v31
    v_dot2_f32_bf16 v31, v75, v19, v31
    ds_write_b32 v27, v30 offset:0
    s_waitcnt vmcnt(36)
    v_dot2_f32_bf16 v29, v76, v8, 0
    v_dot2_f32_bf16 v29, v77, v9, v29
    v_dot2_f32_bf16 v29, v78, v10, v29
    v_dot2_f32_bf16 v29, v79, v11, v29
    ds_write_b32 v28, v31 offset:0
    s_waitcnt vmcnt(35)
    v_dot2_f32_bf16 v30, v80, v12, 0
    v_dot2_f32_bf16 v30, v81, v13, v30
    v_dot2_f32_bf16 v30, v82, v14, v30
    v_dot2_f32_bf16 v30, v83, v15, v30
    ds_write_b32 v26, v29 offset:896
    s_waitcnt vmcnt(34)
    v_dot2_f32_bf16 v31, v84, v16, 0
    v_dot2_f32_bf16 v31, v85, v17, v31
    v_dot2_f32_bf16 v31, v86, v18, v31
    v_dot2_f32_bf16 v31, v87, v19, v31
    ds_write_b32 v27, v30 offset:896
    s_waitcnt vmcnt(33)
    v_dot2_f32_bf16 v29, v88, v8, 0
    v_dot2_f32_bf16 v29, v89, v9, v29
    v_dot2_f32_bf16 v29, v90, v10, v29
    v_dot2_f32_bf16 v29, v91, v11, v29
    ds_write_b32 v28, v31 offset:896
    s_waitcnt vmcnt(32)
    v_dot2_f32_bf16 v30, v92, v12, 0
    v_dot2_f32_bf16 v30, v93, v13, v30
    v_dot2_f32_bf16 v30, v94, v14, v30
    v_dot2_f32_bf16 v30, v95, v15, v30
    ds_write_b32 v26, v29 offset:1792
    s_waitcnt vmcnt(31)
    v_dot2_f32_bf16 v31, v96, v16, 0
    v_dot2_f32_bf16 v31, v97, v17, v31
    v_dot2_f32_bf16 v31, v98, v18, v31
    v_dot2_f32_bf16 v31, v99, v19, v31
    ds_write_b32 v27, v30 offset:1792
    s_waitcnt vmcnt(30)
    v_dot2_f32_bf16 v29, v100, v8, 0
    v_dot2_f32_bf16 v29, v101, v9, v29
    v_dot2_f32_bf16 v29, v102, v10, v29
    v_dot2_f32_bf16 v29, v103, v11, v29
    ds_write_b32 v28, v31 offset:1792
    s_waitcnt vmcnt(29)
    v_dot2_f32_bf16 v30, v104, v12, 0
    v_dot2_f32_bf16 v30, v105, v13, v30
    v_dot2_f32_bf16 v30, v106, v14, v30
    v_dot2_f32_bf16 v30, v107, v15, v30
    ds_write_b32 v26, v29 offset:2688
    s_waitcnt vmcnt(28)
    v_dot2_f32_bf16 v31, v108, v16, 0
    v_dot2_f32_bf16 v31, v109, v17, v31
    v_dot2_f32_bf16 v31, v110, v18, v31
    v_dot2_f32_bf16 v31, v111, v19, v31
    ds_write_b32 v27, v30 offset:2688
    s_waitcnt vmcnt(27)
    v_dot2_f32_bf16 v29, v112, v8, 0
    v_dot2_f32_bf16 v29, v113, v9, v29
    v_dot2_f32_bf16 v29, v114, v10, v29
    v_dot2_f32_bf16 v29, v115, v11, v29
    ds_write_b32 v28, v31 offset:2688
    s_waitcnt vmcnt(26)
    v_dot2_f32_bf16 v30, v116, v12, 0
    v_dot2_f32_bf16 v30, v117, v13, v30
    v_dot2_f32_bf16 v30, v118, v14, v30
    v_dot2_f32_bf16 v30, v119, v15, v30
    ds_write_b32 v26, v29 offset:3584
    s_waitcnt vmcnt(25)
    v_dot2_f32_bf16 v31, v120, v16, 0
    v_dot2_f32_bf16 v31, v121, v17, v31
    v_dot2_f32_bf16 v31, v122, v18, v31
    v_dot2_f32_bf16 v31, v123, v19, v31
    ds_write_b32 v27, v30 offset:3584
    s_waitcnt vmcnt(24)
    v_dot2_f32_bf16 v29, v124, v8, 0
    v_dot2_f32_bf16 v29, v125, v9, v29
    v_dot2_f32_bf16 v29, v126, v10, v29
    v_dot2_f32_bf16 v29, v127, v11, v29
    ds_write_b32 v28, v31 offset:3584
    s_waitcnt vmcnt(23)
    v_dot2_f32_bf16 v30, v128, v12, 0
    v_dot2_f32_bf16 v30, v129, v13, v30
    v_dot2_f32_bf16 v30, v130, v14, v30
    v_dot2_f32_bf16 v30, v131, v15, v30
    ds_write_b32 v26, v29 offset:4480
    s_waitcnt vmcnt(22)
    v_dot2_f32_bf16 v31, v132, v16, 0
    v_dot2_f32_bf16 v31, v133, v17, v31
    v_dot2_f32_bf16 v31, v134, v18, v31
    v_dot2_f32_bf16 v31, v135, v19, v31
    ds_write_b32 v27, v30 offset:4480
    s_waitcnt vmcnt(21)
    v_dot2_f32_bf16 v29, v136, v8, 0
    v_dot2_f32_bf16 v29, v137, v9, v29
    v_dot2_f32_bf16 v29, v138, v10, v29
    v_dot2_f32_bf16 v29, v139, v11, v29
    ds_write_b32 v28, v31 offset:4480
    s_waitcnt vmcnt(20)
    v_dot2_f32_bf16 v30, v140, v12, 0
    v_dot2_f32_bf16 v30, v141, v13, v30
    v_dot2_f32_bf16 v30, v142, v14, v30
    v_dot2_f32_bf16 v30, v143, v15, v30
    ds_write_b32 v26, v29 offset:5376
    s_waitcnt vmcnt(19)
    v_dot2_f32_bf16 v31, v144, v16, 0
    v_dot2_f32_bf16 v31, v145, v17, v31
    v_dot2_f32_bf16 v31, v146, v18, v31
    v_dot2_f32_bf16 v31, v147, v19, v31
    ds_write_b32 v27, v30 offset:5376
    s_waitcnt vmcnt(18)
    v_dot2_f32_bf16 v29, v148, v8, 0
    v_dot2_f32_bf16 v29, v149, v9, v29
    v_dot2_f32_bf16 v29, v150, v10, v29
    v_dot2_f32_bf16 v29, v151, v11, v29
    ds_write_b32 v28, v31 offset:5376
    s_waitcnt vmcnt(17)
    v_dot2_f32_bf16 v30, v152, v12, 0
    v_dot2_f32_bf16 v30, v153, v13, v30
    v_dot2_f32_bf16 v30, v154, v14, v30
    v_dot2_f32_bf16 v30, v155, v15, v30
    ds_write_b32 v26, v29 offset:6272
    s_waitcnt vmcnt(16)
    v_dot2_f32_bf16 v31, v156, v16, 0
    v_dot2_f32_bf16 v31, v157, v17, v31
    v_dot2_f32_bf16 v31, v158, v18, v31
    v_dot2_f32_bf16 v31, v159, v19, v31
    ds_write_b32 v27, v30 offset:6272
    s_nop 2
    ds_write_b32 v28, v31 offset:6272
    s_add_u32 s84, s84, 4096
    buffer_load_dwordx4 v[224:227], v2, s[36:39], s84 offen offset:0 nt
    buffer_load_dwordx4 v[228:231], v2, s[36:39], s84 offen offset:1024 nt
    buffer_load_dwordx4 v[232:235], v2, s[36:39], s84 offen offset:2048 nt
    buffer_load_dwordx4 v[236:239], v2, s[36:39], s84 offen offset:3072 nt
    s_add_u32 s84, s84, 4096
    buffer_load_dwordx4 v[240:243], v2, s[36:39], s84 offen offset:0 nt
    buffer_load_dwordx4 v[244:247], v2, s[36:39], s84 offen offset:1024 nt
    buffer_load_dwordx4 v[248:251], v2, s[36:39], s84 offen offset:2048 nt
    buffer_load_dwordx4 v[252:255], v2, s[36:39], s84 offen offset:3072 nt
    v_mov_b32 v5, 27980
    v_mov_b32 v6, 1
    s_mov_b64 exec, 1
    ds_add_u32 v5, v6
    s_mov_b64 exec, -1
    v_mul_u32_u24 v5, 112, v1
    v_add_u32 v5, s77, v5
    s_waitcnt lgkmcnt(0)
    ds_read_b128 v[64:67], v5 offset:0
    ds_read_b128 v[68:71], v5 offset:16
    ds_read_b128 v[72:75], v5 offset:32
    ds_read_b128 v[76:79], v5 offset:48
    ds_read_b128 v[80:83], v5 offset:64
    ds_read_b128 v[84:87], v5 offset:80
    s_waitcnt lgkmcnt(0)
    v_add_f32 v64, v64, v76
    v_add_f32 v65, v65, v77
    v_add_f32 v66, v66, v78
    v_add_f32 v67, v67, v79
    v_add_f32 v68, v68, v80
    v_add_f32 v69, v69, v81
    v_add_f32 v70, v70, v82
    v_add_f32 v71, v71, v83
    v_add_f32 v72, v72, v84
    v_add_f32 v73, v73, v85
    v_add_f32 v74, v74, v86
    v_add_f32 v75, v75, v87
    v_add_f32 v64, v64, v70
    v_add_f32 v65, v65, v71
    v_add_f32 v66, v66, v72
    v_add_f32 v67, v67, v73
    v_add_f32 v68, v68, v74
    v_add_f32 v69, v69, v75
    v_add_f32 v64, v64, v67
    v_add_f32 v65, v65, v68
    v_add_f32 v66, v66, v69
    v_add_f32 v64, v64, v65
    v_add_f32 v64, v64, v66
    v_mov_b32 v8, v64
    v_cvt_pk_bf16_f32 v8, v8, v8
    v_and_b32 v8, 0xffff0000, v8
    v_mul_f32 v8, 0x3d93cd3a, v8
    v_cvt_pk_bf16_f32 v8, v8, v8
    v_and_b32 v8, 0xffff0000, v8
    v_mov_b32 v9, v8
    s_nop 1
    v_max_f32_dpp v9, v9, v9 quad_perm:[1,0,3,2] row_mask:0xf bank_mask:0xf
    s_nop 1
    v_max_f32_dpp v9, v9, v9 quad_perm:[2,3,0,1] row_mask:0xf bank_mask:0xf
    s_nop 1
    v_max_f32_dpp v9, v9, v9 row_half_mirror row_mask:0xf bank_mask:0xf
    s_nop 1
    v_max_f32_dpp v9, v9, v9 row_mirror row_mask:0xf bank_mask:0xf
    v_mov_b32 v11, v9
    s_nop 1
    v_permlane16_swap_b32 v9, v11
    s_nop 1
    v_max_f32 v9, v9, v11
    v_mov_b32 v11, v9
    s_nop 1
    v_permlane32_swap_b32 v9, v11
    s_nop 1
    v_max_f32 v9, v9, v11
    v_sub_f32 v10, v8, v9
    v_mul_f32 v10, s82, v10
    v_exp_f32 v10, v10
    s_nop 0
    v_mov_b32 v8, v10
    v_cvt_pk_bf16_f32 v8, v8, v8
    v_and_b32 v8, 0xffff0000, v8
    v_and_b32 v11, 7, v1
    v_lshlrev_b32 v11, 5, v11
    v_lshrrev_b32 v5, 3, v1
    v_lshl_add_u32 v11, v5, 2, v11
    s_lshl_b32 s78, s74, 8
    v_add_u32 v11, s78, v11
    ds_write_b32 v11, v8 offset:24576
    s_nop 1
    v_add_f32_dpp v10, v10, v10 quad_perm:[1,0,3,2] row_mask:0xf bank_mask:0xf
    s_nop 1
    v_add_f32_dpp v10, v10, v10 quad_perm:[2,3,0,1] row_mask:0xf bank_mask:0xf
    s_nop 1
    v_add_f32_dpp v10, v10, v10 row_half_mirror row_mask:0xf bank_mask:0xf
    s_nop 1
    v_add_f32_dpp v10, v10, v10 row_mirror row_mask:0xf bank_mask:0xf
    v_mov_b32 v11, v10
    s_nop 1
    v_permlane16_swap_b32 v10, v11
    s_nop 1
    v_add_f32 v10, v10, v11
    v_mov_b32 v11, v10
    s_nop 1
    v_permlane32_swap_b32 v10, v11
    s_nop 1
    v_add_f32 v10, v10, v11
    s_lshl_b32 s79, s74, 3
    v_mov_b32 v11, s79
    v_mov_b32 v8, v9
    v_mov_b32 v9, v10
    ds_write_b64 v11, v[8:9] offset:27264
    s_waitcnt lgkmcnt(0)
    v_lshlrev_b32 v5, 5, v20
    v_add_u32 v5, s78, v5
    ds_read_b128 v[64:67], v5 offset:24576
    ds_read_b128 v[68:71], v5 offset:24592
    v_lshlrev_b32 v5, 5, v21
    v_add_u32 v5, s78, v5
    ds_read_b128 v[72:75], v5 offset:24576
    ds_read_b128 v[76:79], v5 offset:24592
    v_lshlrev_b32 v5, 5, v22
    v_add_u32 v5, s78, v5
    ds_read_b128 v[80:83], v5 offset:24576
    ds_read_b128 v[84:87], v5 offset:24592
    s_waitcnt lgkmcnt(0)
    v_lshrrev_b32 v120, 16, v64
    s_waitcnt vmcnt(23)
    v_dot2_f32_bf16 v96, v160, v120, 0
    v_dot2_f32_bf16 v97, v160, v64, 0
    v_dot2_f32_bf16 v98, v161, v120, 0
    v_dot2_f32_bf16 v99, v161, v64, 0
    v_dot2_f32_bf16 v100, v162, v120, 0
    v_dot2_f32_bf16 v101, v162, v64, 0
    v_dot2_f32_bf16 v102, v163, v120, 0
    v_dot2_f32_bf16 v103, v163, v64, 0
    v_lshrrev_b32 v121, 16, v72
    s_waitcnt vmcnt(22)
    v_dot2_f32_bf16 v104, v164, v121, 0
    v_dot2_f32_bf16 v105, v164, v72, 0
    v_dot2_f32_bf16 v106, v165, v121, 0
    v_dot2_f32_bf16 v107, v165, v72, 0
    v_dot2_f32_bf16 v108, v166, v121, 0
    v_dot2_f32_bf16 v109, v166, v72, 0
    v_dot2_f32_bf16 v110, v167, v121, 0
    v_dot2_f32_bf16 v111, v167, v72, 0
    v_lshrrev_b32 v122, 16, v80
    s_waitcnt vmcnt(21)
    v_dot2_f32_bf16 v112, v168, v122, 0
    v_dot2_f32_bf16 v113, v168, v80, 0
    v_dot2_f32_bf16 v114, v169, v122, 0
    v_dot2_f32_bf16 v115, v169, v80, 0
    v_dot2_f32_bf16 v116, v170, v122, 0
    v_dot2_f32_bf16 v117, v170, v80, 0
    v_dot2_f32_bf16 v118, v171, v122, 0
    v_dot2_f32_bf16 v119, v171, v80, 0
    v_lshrrev_b32 v123, 16, v65
    s_waitcnt vmcnt(20)
    v_dot2_f32_bf16 v96, v172, v123, v96
    v_dot2_f32_bf16 v97, v172, v65, v97
    v_dot2_f32_bf16 v98, v173, v123, v98
    v_dot2_f32_bf16 v99, v173, v65, v99
    v_dot2_f32_bf16 v100, v174, v123, v100
    v_dot2_f32_bf16 v101, v174, v65, v101
    v_dot2_f32_bf16 v102, v175, v123, v102
    v_dot2_f32_bf16 v103, v175, v65, v103
    v_lshrrev_b32 v120, 16, v73
    s_waitcnt vmcnt(19)
    v_dot2_f32_bf16 v104, v176, v120, v104
    v_dot2_f32_bf16 v105, v176, v73, v105
    v_dot2_f32_bf16 v106, v177, v120, v106
    v_dot2_f32_bf16 v107, v177, v73, v107
    v_dot2_f32_bf16 v108, v178, v120, v108
    v_dot2_f32_bf16 v109, v178, v73, v109
    v_dot2_f32_bf16 v110, v179, v120, v110
    v_dot2_f32_bf16 v111, v179, v73, v111
    v_lshrrev_b32 v121, 16, v81
    s_waitcnt vmcnt(18)
    v_dot2_f32_bf16 v112, v180, v121, v112
    v_dot2_f32_bf16 v113, v180, v81, v113
    v_dot2_f32_bf16 v114, v181, v121, v114
    v_dot2_f32_bf16 v115, v181, v81, v115
    v_dot2_f32_bf16 v116, v182, v121, v116
    v_dot2_f32_bf16 v117, v182, v81, v117
    v_dot2_f32_bf16 v118, v183, v121, v118
    v_dot2_f32_bf16 v119, v183, v81, v119
    v_lshrrev_b32 v122, 16, v66
    s_waitcnt vmcnt(17)
    v_dot2_f32_bf16 v96, v184, v122, v96
    v_dot2_f32_bf16 v97, v184, v66, v97
    v_dot2_f32_bf16 v98, v185, v122, v98
    v_dot2_f32_bf16 v99, v185, v66, v99
    v_dot2_f32_bf16 v100, v186, v122, v100
    v_dot2_f32_bf16 v101, v186, v66, v101
    v_dot2_f32_bf16 v102, v187, v122, v102
    v_dot2_f32_bf16 v103, v187, v66, v103
    v_lshrrev_b32 v123, 16, v74
    s_waitcnt vmcnt(16)
    v_dot2_f32_bf16 v104, v188, v123, v104
    v_dot2_f32_bf16 v105, v188, v74, v105
    v_dot2_f32_bf16 v106, v189, v123, v106
    v_dot2_f32_bf16 v107, v189, v74, v107
    v_dot2_f32_bf16 v108, v190, v123, v108
    v_dot2_f32_bf16 v109, v190, v74, v109
    v_dot2_f32_bf16 v110, v191, v123, v110
    v_dot2_f32_bf16 v111, v191, v74, v111
    v_lshrrev_b32 v120, 16, v82
    s_waitcnt vmcnt(15)
    v_dot2_f32_bf16 v112, v192, v120, v112
    v_dot2_f32_bf16 v113, v192, v82, v113
    v_dot2_f32_bf16 v114, v193, v120, v114
    v_dot2_f32_bf16 v115, v193, v82, v115
    v_dot2_f32_bf16 v116, v194, v120, v116
    v_dot2_f32_bf16 v117, v194, v82, v117
    v_dot2_f32_bf16 v118, v195, v120, v118
    v_dot2_f32_bf16 v119, v195, v82, v119
    v_lshrrev_b32 v121, 16, v67
    s_waitcnt vmcnt(14)
    v_dot2_f32_bf16 v96, v196, v121, v96
    v_dot2_f32_bf16 v97, v196, v67, v97
    v_dot2_f32_bf16 v98, v197, v121, v98
    v_dot2_f32_bf16 v99, v197, v67, v99
    v_dot2_f32_bf16 v100, v198, v121, v100
    v_dot2_f32_bf16 v101, v198, v67, v101
    v_dot2_f32_bf16 v102, v199, v121, v102
    v_dot2_f32_bf16 v103, v199, v67, v103
    v_lshrrev_b32 v122, 16, v75
    s_waitcnt vmcnt(13)
    v_dot2_f32_bf16 v104, v200, v122, v104
    v_dot2_f32_bf16 v105, v200, v75, v105
    v_dot2_f32_bf16 v106, v201, v122, v106
    v_dot2_f32_bf16 v107, v201, v75, v107
    v_dot2_f32_bf16 v108, v202, v122, v108
    v_dot2_f32_bf16 v109, v202, v75, v109
    v_dot2_f32_bf16 v110, v203, v122, v110
    v_dot2_f32_bf16 v111, v203, v75, v111
    v_lshrrev_b32 v123, 16, v83
    s_waitcnt vmcnt(12)
    v_dot2_f32_bf16 v112, v204, v123, v112
    v_dot2_f32_bf16 v113, v204, v83, v113
    v_dot2_f32_bf16 v114, v205, v123, v114
    v_dot2_f32_bf16 v115, v205, v83, v115
    v_dot2_f32_bf16 v116, v206, v123, v116
    v_dot2_f32_bf16 v117, v206, v83, v117
    v_dot2_f32_bf16 v118, v207, v123, v118
    v_dot2_f32_bf16 v119, v207, v83, v119
    v_lshrrev_b32 v120, 16, v68
    s_waitcnt vmcnt(11)
    v_dot2_f32_bf16 v96, v208, v120, v96
    v_dot2_f32_bf16 v97, v208, v68, v97
    v_dot2_f32_bf16 v98, v209, v120, v98
    v_dot2_f32_bf16 v99, v209, v68, v99
    v_dot2_f32_bf16 v100, v210, v120, v100
    v_dot2_f32_bf16 v101, v210, v68, v101
    v_dot2_f32_bf16 v102, v211, v120, v102
    v_dot2_f32_bf16 v103, v211, v68, v103
    v_lshrrev_b32 v121, 16, v76
    s_waitcnt vmcnt(10)
    v_dot2_f32_bf16 v104, v212, v121, v104
    v_dot2_f32_bf16 v105, v212, v76, v105
    v_dot2_f32_bf16 v106, v213, v121, v106
    v_dot2_f32_bf16 v107, v213, v76, v107
    v_dot2_f32_bf16 v108, v214, v121, v108
    v_dot2_f32_bf16 v109, v214, v76, v109
    v_dot2_f32_bf16 v110, v215, v121, v110
    v_dot2_f32_bf16 v111, v215, v76, v111
    v_lshrrev_b32 v122, 16, v84
    s_waitcnt vmcnt(9)
    v_dot2_f32_bf16 v112, v216, v122, v112
    v_dot2_f32_bf16 v113, v216, v84, v113
    v_dot2_f32_bf16 v114, v217, v122, v114
    v_dot2_f32_bf16 v115, v217, v84, v115
    v_dot2_f32_bf16 v116, v218, v122, v116
    v_dot2_f32_bf16 v117, v218, v84, v117
    v_dot2_f32_bf16 v118, v219, v122, v118
    v_dot2_f32_bf16 v119, v219, v84, v119
    v_lshrrev_b32 v123, 16, v69
    s_waitcnt vmcnt(8)
    v_dot2_f32_bf16 v96, v220, v123, v96
    v_dot2_f32_bf16 v97, v220, v69, v97
    v_dot2_f32_bf16 v98, v221, v123, v98
    v_dot2_f32_bf16 v99, v221, v69, v99
    v_dot2_f32_bf16 v100, v222, v123, v100
    v_dot2_f32_bf16 v101, v222, v69, v101
    v_dot2_f32_bf16 v102, v223, v123, v102
    v_dot2_f32_bf16 v103, v223, v69, v103
    v_lshrrev_b32 v120, 16, v77
    s_waitcnt vmcnt(7)
    v_dot2_f32_bf16 v104, v224, v120, v104
    v_dot2_f32_bf16 v105, v224, v77, v105
    v_dot2_f32_bf16 v106, v225, v120, v106
    v_dot2_f32_bf16 v107, v225, v77, v107
    v_dot2_f32_bf16 v108, v226, v120, v108
    v_dot2_f32_bf16 v109, v226, v77, v109
    v_dot2_f32_bf16 v110, v227, v120, v110
    v_dot2_f32_bf16 v111, v227, v77, v111
    v_lshrrev_b32 v121, 16, v85
    s_waitcnt vmcnt(6)
    v_dot2_f32_bf16 v112, v228, v121, v112
    v_dot2_f32_bf16 v113, v228, v85, v113
    v_dot2_f32_bf16 v114, v229, v121, v114
    v_dot2_f32_bf16 v115, v229, v85, v115
    v_dot2_f32_bf16 v116, v230, v121, v116
    v_dot2_f32_bf16 v117, v230, v85, v117
    v_dot2_f32_bf16 v118, v231, v121, v118
    v_dot2_f32_bf16 v119, v231, v85, v119
    v_lshrrev_b32 v122, 16, v70
    s_waitcnt vmcnt(5)
    v_dot2_f32_bf16 v96, v232, v122, v96
    v_dot2_f32_bf16 v97, v232, v70, v97
    v_dot2_f32_bf16 v98, v233, v122, v98
    v_dot2_f32_bf16 v99, v233, v70, v99
    v_dot2_f32_bf16 v100, v234, v122, v100
    v_dot2_f32_bf16 v101, v234, v70, v101
    v_dot2_f32_bf16 v102, v235, v122, v102
    v_dot2_f32_bf16 v103, v235, v70, v103
    v_lshrrev_b32 v123, 16, v78
    s_waitcnt vmcnt(4)
    v_dot2_f32_bf16 v104, v236, v123, v104
    v_dot2_f32_bf16 v105, v236, v78, v105
    v_dot2_f32_bf16 v106, v237, v123, v106
    v_dot2_f32_bf16 v107, v237, v78, v107
    v_dot2_f32_bf16 v108, v238, v123, v108
    v_dot2_f32_bf16 v109, v238, v78, v109
    v_dot2_f32_bf16 v110, v239, v123, v110
    v_dot2_f32_bf16 v111, v239, v78, v111
    v_lshrrev_b32 v120, 16, v86
    s_waitcnt vmcnt(3)
    v_dot2_f32_bf16 v112, v240, v120, v112
    v_dot2_f32_bf16 v113, v240, v86, v113
    v_dot2_f32_bf16 v114, v241, v120, v114
    v_dot2_f32_bf16 v115, v241, v86, v115
    v_dot2_f32_bf16 v116, v242, v120, v116
    v_dot2_f32_bf16 v117, v242, v86, v117
    v_dot2_f32_bf16 v118, v243, v120, v118
    v_dot2_f32_bf16 v119, v243, v86, v119
    v_lshrrev_b32 v121, 16, v71
    s_waitcnt vmcnt(2)
    v_dot2_f32_bf16 v96, v244, v121, v96
    v_dot2_f32_bf16 v97, v244, v71, v97
    v_dot2_f32_bf16 v98, v245, v121, v98
    v_dot2_f32_bf16 v99, v245, v71, v99
    v_dot2_f32_bf16 v100, v246, v121, v100
    v_dot2_f32_bf16 v101, v246, v71, v101
    v_dot2_f32_bf16 v102, v247, v121, v102
    v_dot2_f32_bf16 v103, v247, v71, v103
    v_lshrrev_b32 v122, 16, v79
    s_waitcnt vmcnt(1)
    v_dot2_f32_bf16 v104, v248, v122, v104
    v_dot2_f32_bf16 v105, v248, v79, v105
    v_dot2_f32_bf16 v106, v249, v122, v106
    v_dot2_f32_bf16 v107, v249, v79, v107
    v_dot2_f32_bf16 v108, v250, v122, v108
    v_dot2_f32_bf16 v109, v250, v79, v109
    v_dot2_f32_bf16 v110, v251, v122, v110
    v_dot2_f32_bf16 v111, v251, v79, v111
    v_lshrrev_b32 v123, 16, v87
    s_waitcnt vmcnt(0)
    v_dot2_f32_bf16 v112, v252, v123, v112
    v_dot2_f32_bf16 v113, v252, v87, v113
    v_dot2_f32_bf16 v114, v253, v123, v114
    v_dot2_f32_bf16 v115, v253, v87, v115
    v_dot2_f32_bf16 v116, v254, v123, v116
    v_dot2_f32_bf16 v117, v254, v87, v117
    v_dot2_f32_bf16 v118, v255, v123, v118
    v_dot2_f32_bf16 v119, v255, v87, v119
    v_lshlrev_b32 v5, 5, v1
    v_add_u32 v5, s77, v5
    s_nop 0
    ds_write_b128 v5, v[96:99] offset:0
    ds_write_b128 v5, v[100:103] offset:16
    ds_write_b128 v5, v[104:107] offset:2048
    ds_write_b128 v5, v[108:111] offset:2064
    ds_write_b128 v5, v[112:115] offset:4096
    ds_write_b128 v5, v[116:119] offset:4112
    s_cmp_ge_u32 s74, 5
    s_cbranch_scc1 L_nowo
    s_mov_b32 s85, s74
    s_cmp_eq_u32 s74, 4
    s_cbranch_scc1 L_wogo
    v_mov_b32 v7, 27980
    s_mov_b32 s81, 0
L_c2wait:
    ds_read_b32 v6, v7
    s_waitcnt lgkmcnt(0)
    v_readfirstlane_b32 s78, v6
    s_cmp_eq_u32 s78, 8
    s_cbranch_scc1 L_wogo
    s_add_u32 s81, s81, 1
    s_cmp_gt_u32 s81, 4000000
    s_cbranch_scc1 L_wogo
    s_sleep 1
    s_branch L_c2wait
L_wogo:
    v_lshrrev_b32 v6, 3, v1
    v_mul_u32_u24 v6, 1280, v6
    v_and_b32 v7, 7, v1
    v_lshl_add_u32 v6, v7, 4, v6
    s_and_b32 s79, s73, 1
    s_mul_i32 s79, s79, 640
    s_lshl_b32 s78, s85, 7
    s_add_u32 s79, s79, s78
    s_lshr_b32 s80, s73, 1
    s_mul_i32 s78, s72, 192
    s_mul_i32 s88, s80, 48
    s_add_u32 s78, s78, s88
    s_mul_i32 s78, s78, 1280
    s_add_u32 s78, s78, s79
    buffer_load_dwordx4 v[32:35], v6, s[44:47], s78 offen nt
    s_add_u32 s78, s78, 10240
    buffer_load_dwordx4 v[36:39], v6, s[44:47], s78 offen nt
    s_add_u32 s78, s78, 10240
    buffer_load_dwordx4 v[40:43], v6, s[44:47], s78 offen nt
    s_add_u32 s78, s78, 10240
    buffer_load_dwordx4 v[44:47], v6, s[44:47], s78 offen nt
    s_add_u32 s78, s78, 10240
    buffer_load_dwordx4 v[48:51], v6, s[44:47], s78 offen nt
    s_add_u32 s78, s78, 10240
    buffer_load_dwordx4 v[52:55], v6, s[44:47], s78 offen nt
    s_lshl_b32 s78, s72, 2
    s_add_u32 s78, s78, s80
    s_mul_i32 s78, s78, 15360
    s_add_u32 s78, s78, s79
    buffer_load_dwordx4 v[56:59], v6, s[52:55], s78 offen nt
    s_add_u32 s78, s78, 10240
    s_mov_b32 exec_hi, 0
    buffer_load_dwordx4 v[60:63], v6, s[52:55], s78 offen nt
    s_mov_b64 exec, -1
L_nowo:
    s_waitcnt lgkmcnt(0)
    s_barrier
    s_cmp_ge_u32 s74, 6
    s_cbranch_scc1 L_nopub2
    v_and_b32 v8, 7, v1
    v_lshrrev_b32 v6, 3, v0
    v_mul_u32_u24 v5, 7200, v8
    v_lshl_add_u32 v5, v6, 4, v5
    v_add_u32 v5, 32768, v5
    v_lshlrev_b32 v7, 3, v8
    ds_read_b64 v[10:11], v7 offset:27264
    ds_read_b128 v[64:67], v5 offset:0
    ds_read_b128 v[68:71], v5 offset:768
    ds_read_b128 v[72:75], v5 offset:1536
    ds_read_b128 v[76:79], v5 offset:2304
    ds_read_b128 v[80:83], v5 offset:3072
    ds_read_b128 v[84:87], v5 offset:3840
    ds_read_b128 v[88:91], v5 offset:4608
    ds_read_b128 v[92:95], v5 offset:5376
    s_waitcnt lgkmcnt(8)
    v_mov_b32 v12, v10
    s_nop 1
    v_max_f32_dpp v12, v12, v12 quad_perm:[1,0,3,2] row_mask:0xf bank_mask:0xf
    s_nop 1
    v_max_f32_dpp v12, v12, v12 quad_perm:[2,3,0,1] row_mask:0xf bank_mask:0xf
    s_nop 1
    v_max_f32_dpp v12, v12, v12 row_half_mirror row_mask:0xf bank_mask:0xf
    v_sub_f32 v10, v10, v12
    v_mul_f32 v10, s82, v10
    v_exp_f32 v10, v10
    s_waitcnt lgkmcnt(0)
    v_add_f32 v64, v64, v80
    v_add_f32 v65, v65, v81
    v_add_f32 v66, v66, v82
    v_add_f32 v67, v67, v83
    v_add_f32 v68, v68, v84
    v_add_f32 v69, v69, v85
    v_add_f32 v70, v70, v86
    v_add_f32 v71, v71, v87
    v_add_f32 v72, v72, v88
    v_add_f32 v73, v73, v89
    v_add_f32 v74, v74, v90
    v_add_f32 v75, v75, v91
    v_add_f32 v76, v76, v92
    v_add_f32 v77, v77, v93
    v_add_f32 v78, v78, v94
    v_add_f32 v79, v79, v95
    v_add_f32 v64, v64, v72
    v_add_f32 v65, v65, v73
    v_add_f32 v66, v66, v74
    v_add_f32 v67, v67, v75
    v_add_f32 v68, v68, v76
    v_add_f32 v69, v69, v77
    v_add_f32 v70, v70, v78
    v_add_f32 v71, v71, v79
    v_add_f32 v64, v64, v68
    v_add_f32 v65, v65, v69
    v_add_f32 v66, v66, v70
    v_add_f32 v67, v67, v71
    v_mul_f32 v64, v64, v10
    v_mul_f32 v65, v65, v10
    v_mul_f32 v66, v66, v10
    v_mul_f32 v67, v67, v10
    v_mul_f32 v11, v11, v10
    s_nop 1
    v_add_f32_dpp v64, v64, v64 quad_perm:[1,0,3,2] row_mask:0xf bank_mask:0xf
    v_add_f32_dpp v65, v65, v65 quad_perm:[1,0,3,2] row_mask:0xf bank_mask:0xf
    v_add_f32_dpp v66, v66, v66 quad_perm:[1,0,3,2] row_mask:0xf bank_mask:0xf
    v_add_f32_dpp v67, v67, v67 quad_perm:[1,0,3,2] row_mask:0xf bank_mask:0xf
    v_add_f32_dpp v11, v11, v11 quad_perm:[1,0,3,2] row_mask:0xf bank_mask:0xf
    s_nop 1
    v_add_f32_dpp v64, v64, v64 quad_perm:[2,3,0,1] row_mask:0xf bank_mask:0xf
    v_add_f32_dpp v65, v65, v65 quad_perm:[2,3,0,1] row_mask:0xf bank_mask:0xf
    v_add_f32_dpp v66, v66, v66 quad_perm:[2,3,0,1] row_mask:0xf bank_mask:0xf
    v_add_f32_dpp v67, v67, v67 quad_perm:[2,3,0,1] row_mask:0xf bank_mask:0xf
    v_add_f32_dpp v11, v11, v11 quad_perm:[2,3,0,1] row_mask:0xf bank_mask:0xf
    s_nop 1
    v_add_f32_dpp v64, v64, v64 row_half_mirror row_mask:0xf bank_mask:0xf
    v_add_f32_dpp v65, v65, v65 row_half_mirror row_mask:0xf bank_mask:0xf
    v_add_f32_dpp v66, v66, v66 row_half_mirror row_mask:0xf bank_mask:0xf
    v_add_f32_dpp v67, v67, v67 row_half_mirror row_mask:0xf bank_mask:0xf
    v_add_f32_dpp v11, v11, v11 row_half_mirror row_mask:0xf bank_mask:0xf
    v_cmp_eq_u32 vcc, 1, v8
    s_nop 1
    v_cndmask_b32 v16, v64, v66, vcc
    v_cndmask_b32 v18, v65, v67, vcc
    v_lshl_add_u32 v5, v6, 1, v8
    v_cmp_eq_u32 vcc, 2, v0
    s_nop 1
    v_cndmask_b32 v16, v16, v12, vcc
    v_cndmask_b32 v18, v18, v11, vcc
    v_mov_b32 v6, 96
    v_cndmask_b32 v5, v5, v6, vcc
    v_cmp_gt_u32 s[88:89], 2, v8
    s_or_b64 vcc, vcc, s[88:89]
    v_mov_b32 v17, s75
    v_mov_b32 v19, s75
    s_lshl_b32 s77, s76, 11
    s_add_u32 s77, s77, 790528
    v_lshlrev_b32 v5, 4, v5
    s_and_saveexec_b64 s[88:89], vcc
    buffer_store_dwordx4 v[16:19], v5, s[68:71], s77 offen sc1
    s_mov_b64 exec, s[88:89]
L_nopub2:
    s_cmp_ge_u32 s74, 5
    s_cbranch_scc1 L_poller
    v_lshrrev_b32 v5, 3, v1
    v_lshlrev_b32 v5, 2, v5
    v_mov_b32 v7, 27200
    ds_read_b32 v94, v5 offset:27136
    ds_read_b32 v95, v5 offset:27168
    ds_read_b64 v[12:13], v7
    s_mul_i32 s77, s76, 2560
    s_lshl_b32 s78, s85, 9
    s_add_u32 s77, s77, s78
    s_add_u32 s77, s77, 1314816
    v_and_b32 v14, 7, v1
    v_lshlrev_b32 v14, 6, v14
    v_lshrrev_b32 v15, 4, v1
    v_lshl_add_u32 v14, v15, 4, v14
    s_waitcnt vmcnt(0) lgkmcnt(0)
    v_lshrrev_b32 v6, 16, v94
    v_dot2_f32_bf16 v104, v56, v6, 0
    v_dot2_f32_bf16 v105, v56, v94, 0
    v_dot2_f32_bf16 v106, v57, v6, 0
    v_dot2_f32_bf16 v107, v57, v94, 0
    v_dot2_f32_bf16 v108, v58, v6, 0
    v_dot2_f32_bf16 v109, v58, v94, 0
    v_dot2_f32_bf16 v110, v59, v6, 0
    v_dot2_f32_bf16 v111, v59, v94, 0
    s_mov_b32 exec_hi, 0
    v_lshrrev_b32 v6, 16, v95
    v_dot2_f32_bf16 v104, v60, v6, v104
    v_dot2_f32_bf16 v105, v60, v95, v105
    v_dot2_f32_bf16 v106, v61, v6, v106
    v_dot2_f32_bf16 v107, v61, v95, v107
    v_dot2_f32_bf16 v108, v62, v6, v108
    v_dot2_f32_bf16 v109, v62, v95, v109
    v_dot2_f32_bf16 v110, v63, v6, v110
    v_dot2_f32_bf16 v111, v63, v95, v111
    s_mov_b64 exec, -1
    s_nop 2
    v_mul_f32 v104, v104, v13
    v_mul_f32 v105, v105, v13
    v_mul_f32 v106, v106, v13
    v_mul_f32 v107, v107, v13
    v_mul_f32 v108, v108, v13
    v_mul_f32 v109, v109, v13
    v_mul_f32 v110, v110, v13
    v_mul_f32 v111, v111, v13
    v_mov_b32 v113, s75
    v_mov_b32 v115, s75
    v_mov_b32 v7, 27976
    s_mov_b32 s81, 0
L_wwait:
    ds_read_b32 v6, v7
    s_waitcnt lgkmcnt(0)
    v_readfirstlane_b32 s78, v6
    s_cmp_lg_u32 s78, 0
    s_cbranch_scc1 L_wready
    s_add_u32 s81, s81, 1
    s_cmp_gt_u32 s81, 4000000
    s_cbranch_scc1 L_wready
    s_branch L_wwait
L_wready:
    ds_read_b32 v88, v5 offset:27328
    ds_read_b32 v89, v5 offset:27360
    ds_read_b32 v90, v5 offset:27392
    ds_read_b32 v91, v5 offset:27424
    ds_read_b32 v92, v5 offset:27456
    ds_read_b32 v93, v5 offset:27488
    s_waitcnt lgkmcnt(5)
    v_lshrrev_b32 v6, 16, v88
    v_dot2_f32_bf16 v96, v32, v6, 0
    v_dot2_f32_bf16 v97, v32, v88, 0
    v_dot2_f32_bf16 v98, v33, v6, 0
    v_dot2_f32_bf16 v99, v33, v88, 0
    v_dot2_f32_bf16 v100, v34, v6, 0
    v_dot2_f32_bf16 v101, v34, v88, 0
    v_dot2_f32_bf16 v102, v35, v6, 0
    v_dot2_f32_bf16 v103, v35, v88, 0
    s_waitcnt lgkmcnt(4)
    v_lshrrev_b32 v6, 16, v89
    v_dot2_f32_bf16 v96, v36, v6, v96
    v_dot2_f32_bf16 v97, v36, v89, v97
    v_dot2_f32_bf16 v98, v37, v6, v98
    v_dot2_f32_bf16 v99, v37, v89, v99
    v_dot2_f32_bf16 v100, v38, v6, v100
    v_dot2_f32_bf16 v101, v38, v89, v101
    v_dot2_f32_bf16 v102, v39, v6, v102
    v_dot2_f32_bf16 v103, v39, v89, v103
    s_waitcnt lgkmcnt(3)
    v_lshrrev_b32 v6, 16, v90
    v_dot2_f32_bf16 v96, v40, v6, v96
    v_dot2_f32_bf16 v97, v40, v90, v97
    v_dot2_f32_bf16 v98, v41, v6, v98
    v_dot2_f32_bf16 v99, v41, v90, v99
    v_dot2_f32_bf16 v100, v42, v6, v100
    v_dot2_f32_bf16 v101, v42, v90, v101
    v_dot2_f32_bf16 v102, v43, v6, v102
    v_dot2_f32_bf16 v103, v43, v90, v103
    s_waitcnt lgkmcnt(2)
    v_lshrrev_b32 v6, 16, v91
    v_dot2_f32_bf16 v96, v44, v6, v96
    v_dot2_f32_bf16 v97, v44, v91, v97
    v_dot2_f32_bf16 v98, v45, v6, v98
    v_dot2_f32_bf16 v99, v45, v91, v99
    v_dot2_f32_bf16 v100, v46, v6, v100
    v_dot2_f32_bf16 v101, v46, v91, v101
    v_dot2_f32_bf16 v102, v47, v6, v102
    v_dot2_f32_bf16 v103, v47, v91, v103
    s_waitcnt lgkmcnt(1)
    v_lshrrev_b32 v6, 16, v92
    v_dot2_f32_bf16 v96, v48, v6, v96
    v_dot2_f32_bf16 v97, v48, v92, v97
    v_dot2_f32_bf16 v98, v49, v6, v98
    v_dot2_f32_bf16 v99, v49, v92, v99
    v_dot2_f32_bf16 v100, v50, v6, v100
    v_dot2_f32_bf16 v101, v50, v92, v101
    v_dot2_f32_bf16 v102, v51, v6, v102
    v_dot2_f32_bf16 v103, v51, v92, v103
    s_waitcnt lgkmcnt(0)
    v_lshrrev_b32 v6, 16, v93
    v_dot2_f32_bf16 v96, v52, v6, v96
    v_dot2_f32_bf16 v97, v52, v93, v97
    v_dot2_f32_bf16 v98, v53, v6, v98
    v_dot2_f32_bf16 v99, v53, v93, v99
    v_dot2_f32_bf16 v100, v54, v6, v100
    v_dot2_f32_bf16 v101, v54, v93, v101
    v_dot2_f32_bf16 v102, v55, v6, v102
    v_dot2_f32_bf16 v103, v55, v93, v103
    s_nop 2
    v_fma_f32 v96, v96, v12, v104
    v_fma_f32 v97, v97, v12, v105
    v_fma_f32 v98, v98, v12, v106
    v_fma_f32 v99, v99, v12, v107
    v_fma_f32 v100, v100, v12, v108
    v_fma_f32 v101, v101, v12, v109
    v_fma_f32 v102, v102, v12, v110
    v_fma_f32 v103, v103, v12, v111
    s_nop 1
    v_permlane32_swap_b32 v96, v100
    v_permlane32_swap_b32 v97, v101
    v_permlane32_swap_b32 v98, v102
    v_permlane32_swap_b32 v99, v103
    s_nop 1
    v_add_f32 v96, v96, v100
    v_add_f32 v97, v97, v101
    v_add_f32 v98, v98, v102
    v_add_f32 v99, v99, v103
    s_nop 1
    v_permlane16_swap_b32 v96, v98
    v_permlane16_swap_b32 v97, v99
    s_nop 1
    v_add_f32 v112, v96, v98
    v_add_f32 v114, v97, v99
    s_nop 1
    v_add_f32_dpp v112, v112, v112 row_ror:8 row_mask:0xf bank_mask:0xf
    v_add_f32_dpp v114, v114, v114 row_ror:8 row_mask:0xf bank_mask:0xf
    s_mov_b32 exec_lo, 0x00ff00ff
    s_mov_b32 exec_hi, 0x00ff00ff
    buffer_store_dwordx4 v[112:115], v14, s[68:71], s77 offen sc1
    s_branch L_fin
L_poller:
    s_cmp_lg_u32 s74, 7
    s_cbranch_scc1 L_fin
    v_and_b32 v10, 7, v1
    v_lshlrev_b32 v10, 16, v10
    v_lshrrev_b32 v6, 3, v1
    v_lshl_add_u32 v8, v6, 4, v10
    s_lshl_b32 s77, s72, 11
    s_add_u32 s77, s77, 790528
    s_lshr_b32 s78, s73, 1
    s_mul_i32 s78, s78, 384
    s_add_u32 s78, s78, s77
    s_mov_b32 s81, 0
    buffer_load_dwordx4 v[160:163], v8, s[68:71], s78 offen sc1
    buffer_load_dwordx4 v[164:167], v8, s[68:71], s78 offen offset:128 sc1
    buffer_load_dwordx4 v[168:171], v8, s[68:71], s78 offen offset:256 sc1
    buffer_load_dwordx4 v[172:175], v10, s[68:71], s77 offen offset:1536 sc1
L_poll1:
    s_waitcnt vmcnt(0)
    v_xor_b32 v6, s75, v161
    v_xor_b32 v7, s75, v163
    v_or_b32 v6, v6, v7
    v_xor_b32 v7, s75, v165
    v_or_b32 v6, v6, v7
    v_xor_b32 v7, s75, v167
    v_or_b32 v6, v6, v7
    v_xor_b32 v7, s75, v169
    v_or_b32 v6, v6, v7
    v_xor_b32 v7, s75, v171
    v_or_b32 v6, v6, v7
    v_xor_b32 v7, s75, v173
    v_or_b32 v6, v6, v7
    v_xor_b32 v7, s75, v175
    v_or_b32 v6, v6, v7
    v_cmp_ne_u32 vcc, 0, v6
    s_nop 1
    s_cmp_eq_u64 vcc, 0
    s_cbranch_scc1 L_p1ok0
    buffer_load_dwordx4 v[160:163], v8, s[68:71], s78 offen sc1
    buffer_load_dwordx4 v[164:167], v8, s[68:71], s78 offen offset:128 sc1
    buffer_load_dwordx4 v[168:171], v8, s[68:71], s78 offen offset:256 sc1
    buffer_load_dwordx4 v[172:175], v10, s[68:71], s77 offen offset:1536 sc1
    s_add_u32 s81, s81, 1
    s_cmp_lt_u32 s81, 100000
    s_cbranch_scc1 L_poll1
L_p1ok0:
    v_mov_b32 v64, v160
    v_mov_b32 v66, v162
    v_mov_b32 v68, v164
    v_mov_b32 v70, v166
    v_mov_b32 v72, v168
    v_mov_b32 v74, v170
    v_mov_b32 v76, v172
    v_mov_b32 v78, v174
L_p1done:
    v_mov_b32 v12, v76
    s_nop 1
    v_max_f32_dpp v12, v12, v12 quad_perm:[1,0,3,2] row_mask:0xf bank_mask:0xf
    s_nop 1
    v_max_f32_dpp v12, v12, v12 quad_perm:[2,3,0,1] row_mask:0xf bank_mask:0xf
    s_nop 1
    v_max_f32_dpp v12, v12, v12 row_half_mirror row_mask:0xf bank_mask:0xf
    v_sub_f32 v12, v76, v12
    v_mul_f32 v12, s82, v12
    v_exp_f32 v12, v12
    s_nop 0
    v_mul_f32 v78, v78, v12
    v_mul_f32 v64, v64, v12
    v_mul_f32 v66, v66, v12
    v_mul_f32 v68, v68, v12
    v_mul_f32 v70, v70, v12
    v_mul_f32 v72, v72, v12
    v_mul_f32 v74, v74, v12
    s_nop 1
    v_add_f32_dpp v78, v78, v78 quad_perm:[1,0,3,2] row_mask:0xf bank_mask:0xf
    v_add_f32_dpp v64, v64, v64 quad_perm:[1,0,3,2] row_mask:0xf bank_mask:0xf
    v_add_f32_dpp v66, v66, v66 quad_perm:[1,0,3,2] row_mask:0xf bank_mask:0xf
    v_add_f32_dpp v68, v68, v68 quad_perm:[1,0,3,2] row_mask:0xf bank_mask:0xf
    v_add_f32_dpp v70, v70, v70 quad_perm:[1,0,3,2] row_mask:0xf bank_mask:0xf
    v_add_f32_dpp v72, v72, v72 quad_perm:[1,0,3,2] row_mask:0xf bank_mask:0xf
    v_add_f32_dpp v74, v74, v74 quad_perm:[1,0,3,2] row_mask:0xf bank_mask:0xf
    s_nop 1
    v_add_f32_dpp v78, v78, v78 quad_perm:[2,3,0,1] row_mask:0xf bank_mask:0xf
    v_add_f32_dpp v64, v64, v64 quad_perm:[2,3,0,1] row_mask:0xf bank_mask:0xf
    v_add_f32_dpp v66, v66, v66 quad_perm:[2,3,0,1] row_mask:0xf bank_mask:0xf
    v_add_f32_dpp v68, v68, v68 quad_perm:[2,3,0,1] row_mask:0xf bank_mask:0xf
    v_add_f32_dpp v70, v70, v70 quad_perm:[2,3,0,1] row_mask:0xf bank_mask:0xf
    v_add_f32_dpp v72, v72, v72 quad_perm:[2,3,0,1] row_mask:0xf bank_mask:0xf
    v_add_f32_dpp v74, v74, v74 quad_perm:[2,3,0,1] row_mask:0xf bank_mask:0xf
    s_nop 1
    v_add_f32_dpp v78, v78, v78 row_half_mirror row_mask:0xf bank_mask:0xf
    v_add_f32_dpp v64, v64, v64 row_half_mirror row_mask:0xf bank_mask:0xf
    v_add_f32_dpp v66, v66, v66 row_half_mirror row_mask:0xf bank_mask:0xf
    v_add_f32_dpp v68, v68, v68 row_half_mirror row_mask:0xf bank_mask:0xf
    v_add_f32_dpp v70, v70, v70 row_half_mirror row_mask:0xf bank_mask:0xf
    v_add_f32_dpp v72, v72, v72 row_half_mirror row_mask:0xf bank_mask:0xf
    v_add_f32_dpp v74, v74, v74 row_half_mirror row_mask:0xf bank_mask:0xf
    v_rcp_f32 v12, v78
    v_lshrrev_b32 v5, 3, v1
    v_lshlrev_b32 v5, 3, v5
    v_mul_f32 v64, v64, v12
    v_mul_f32 v66, v66, v12
    v_mul_f32 v68, v68, v12
    v_mul_f32 v70, v70, v12
    v_mul_f32 v72, v72, v12
    v_mul_f32 v74, v74, v12
    v_cvt_pk_bf16_f32 v66, v64, v66
    v_cvt_pk_bf16_f32 v70, v68, v70
    v_cvt_pk_bf16_f32 v74, v72, v74
    v_lshlrev_b32 v64, 16, v66
    v_and_b32 v65, 0xffff0000, v66
    v_lshlrev_b32 v68, 16, v70
    v_and_b32 v69, 0xffff0000, v70
    v_lshlrev_b32 v72, 16, v74
    v_and_b32 v73, 0xffff0000, v74
    s_mov_b32 exec_lo, 0x01010101
    s_mov_b32 exec_hi, 0x01010101
    ds_write_b64 v5, v[64:65] offset:27328
    ds_write_b64 v5, v[68:69] offset:27392
    ds_write_b64 v5, v[72:73] offset:27456
    s_waitcnt lgkmcnt(0)
    v_mov_b32 v5, 27976
    v_mov_b32 v6, 1
    ds_write_b32 v5, v6
    s_mov_b64 exec, -1
    s_cmp_ge_u32 s76, 160
    s_cbranch_scc1 L_fin
    v_bfe_u32 v5, v1, 1, 2
    v_lshlrev_b32 v5, 3, v5
    v_bfe_u32 v6, v1, 3, 1
    v_add_u32 v5, v5, v6
    v_lshrrev_b32 v6, 4, v1
    v_lshl_add_u32 v5, v6, 6, v5
    v_mul_u32_u24 v5, 2560, v5
    v_and_b32 v6, 1, v1
    v_lshl_add_u32 v5, v6, 4, v5
    s_cmp_ge_u32 s76, 80
    s_cselect_b32 s78, 1, 0
    s_mul_i32 s77, s78, 80
    s_sub_u32 s77, s76, s77
    s_lshl_b32 s77, s77, 5
    s_mul_i32 s78, s78, 81920
    s_add_u32 s77, s77, s78
    s_add_u32 s40, s77, 1314816
    s_add_u32 s41, s40, 5120
    s_add_u32 s42, s41, 5120
    s_add_u32 s43, s42, 5120
    s_mov_b32 s79, 0
    s_mov_b32 s81, 0
L_poll2:
    s_bitcmp1_b32 s79, 0
    s_cbranch_scc1 L_sk_3
    buffer_load_dwordx4 v[128:131], v5, s[68:71], s40 offen sc1
L_sk_3:
    s_bitcmp1_b32 s79, 1
    s_cbranch_scc1 L_sk_4
    buffer_load_dwordx4 v[132:135], v5, s[68:71], s41 offen sc1
L_sk_4:
    s_bitcmp1_b32 s79, 2
    s_cbranch_scc1 L_sk_5
    buffer_load_dwordx4 v[136:139], v5, s[68:71], s42 offen sc1
L_sk_5:
    s_bitcmp1_b32 s79, 3
    s_cbranch_scc1 L_sk_6
    buffer_load_dwordx4 v[140:143], v5, s[68:71], s43 offen sc1
L_sk_6:
    s_waitcnt vmcnt(0)
    v_xor_b32 v6, s75, v129
    v_xor_b32 v7, s75, v131
    v_or_b32 v6, v6, v7
    v_cmp_ne_u32 vcc, 0, v6
    s_nop 1
    s_cmp_eq_u64 vcc, 0
    s_cselect_b32 s78, 1, 0
    s_or_b32 s79, s79, s78
    v_xor_b32 v6, s75, v133
    v_xor_b32 v7, s75, v135
    v_or_b32 v6, v6, v7
    v_cmp_ne_u32 vcc, 0, v6
    s_nop 1
    s_cmp_eq_u64 vcc, 0
    s_cselect_b32 s78, 2, 0
    s_or_b32 s79, s79, s78
    v_xor_b32 v6, s75, v137
    v_xor_b32 v7, s75, v139
    v_or_b32 v6, v6, v7
    v_cmp_ne_u32 vcc, 0, v6
    s_nop 1
    s_cmp_eq_u64 vcc, 0
    s_cselect_b32 s78, 4, 0
    s_or_b32 s79, s79, s78
    v_xor_b32 v6, s75, v141
    v_xor_b32 v7, s75, v143
    v_or_b32 v6, v6, v7
    v_cmp_ne_u32 vcc, 0, v6
    s_nop 1
    s_cmp_eq_u64 vcc, 0
    s_cselect_b32 s78, 8, 0
    s_or_b32 s79, s79, s78
    s_cmp_eq_u32 s79, 0xf
    s_cbranch_scc1 L_p2done
    s_add_u32 s81, s81, 1
    s_cmp_lt_u32 s81, 200000
    s_cbranch_scc0 L_p2done
    s_branch L_poll2
L_p2done:
    v_add_f32 v128, v128, v132
    v_add_f32 v130, v130, v134
    v_add_f32 v128, v128, v136
    v_add_f32 v130, v130, v138
    v_add_f32 v128, v128, v140
    v_add_f32 v130, v130, v142
    s_nop 1
    v_add_f32_dpp v128, v128, v128 quad_perm:[2,3,0,1] row_mask:0xf bank_mask:0xf
    v_add_f32_dpp v130, v130, v130 quad_perm:[2,3,0,1] row_mask:0xf bank_mask:0xf
    s_nop 1
    v_add_f32_dpp v128, v128, v128 row_ror:4 row_mask:0xf bank_mask:0xf
    v_add_f32_dpp v130, v130, v130 row_ror:4 row_mask:0xf bank_mask:0xf
    s_nop 1
    v_add_f32_dpp v128, v128, v128 row_ror:8 row_mask:0xf bank_mask:0xf
    v_add_f32_dpp v130, v130, v130 row_ror:8 row_mask:0xf bank_mask:0xf
    v_mov_b32 v129, v128
    v_mov_b32 v131, v130
    s_nop 1
    v_permlane16_swap_b32 v128, v129
    v_permlane16_swap_b32 v130, v131
    s_nop 1
    v_add_f32 v128, v128, v129
    v_add_f32 v130, v130, v131
    v_mov_b32 v129, v128
    v_mov_b32 v131, v130
    s_nop 1
    v_permlane32_swap_b32 v128, v129
    v_permlane32_swap_b32 v130, v131
    s_nop 1
    v_add_f32 v128, v128, v129
    v_add_f32 v130, v130, v131
    v_cvt_pk_bf16_f32 v128, v128, v130
    v_lshlrev_b32 v5, 2, v1
    s_lshl_b32 s77, s76, 3
    s_mov_b64 exec, 3
    buffer_store_dword v128, v5, s[64:67], s77 offen
    s_cmp_lg_u32 s76, 0
    s_cbranch_scc1 L_fin
    s_mov_b64 exec, 1
    v_mov_b32 v5, s75
    v_mov_b32 v6, 0
    buffer_store_dword v5, v6, s[68:71], 0 offen
L_fin:
L_end:
    s_endpgm
.section .rodata,"a"
.p2align 6
.amdhsa_kernel gated_mix__sliding_block_cached__glu_gated_reglu__decode_kernel
  .amdhsa_next_free_vgpr 256
  .amdhsa_next_free_sgpr 102
  .amdhsa_accum_offset 256
  .amdhsa_group_segment_fixed_size 0
  .amdhsa_kernarg_size 104
  .amdhsa_user_sgpr_count 2
  .amdhsa_user_sgpr_kernarg_segment_ptr 1
  .amdhsa_system_sgpr_workgroup_id_x 1
.end_amdhsa_kernel
```
